```python
import torch

def _softmax(x, axis=-1):
    return torch.softmax(x, dim=axis)
def _gelu(x):
    return torch.nn.functional.gelu(x, approximate="tanh")
def _silu(x):
    return torch.nn.functional.silu(x)
def _sigmoid(x):
    return torch.sigmoid(x)
def _layernorm(x, axis=-1, eps=1e-5):
    m = x.mean(dim=axis, keepdim=True)
    v = x.var(dim=axis, keepdim=True, unbiased=False)
    return (x - m) / torch.sqrt(v + eps)
def _scatter_add(tgt, idx, src, axis=0):
    return tgt.clone().index_add_(axis, idx, src)
def _segment_sum(src, seg, n):
    out = torch.zeros((n,) + src.shape[1:], dtype=src.dtype)
    return out.index_add_(0, seg, src)
def _pad(x, pw):
    flat = tuple(v for pair in reversed(pw) for v in pair)
    return torch.nn.functional.pad(x, flat)

kernel_name = 'gated_mix__spectral_gfnet__glu_gated_geglu__prompt'

def setup_inputs():

    _w = (lambda a: (lambda t: t.to(torch.bfloat16) if t.is_floating_point() else t)(torch.as_tensor(a)))
    def _A_setup():
        B, S, D = 1, 2048, 512
        Df = D // 2 + 1
        return {
            "x": _w((lambda *s: torch.randn(*s, dtype=torch.bfloat16) * 0.05)(B, S, D)),
            "w_r": _w((lambda *s: torch.randn(*s, dtype=torch.bfloat16) * 0.05)(S, Df) * 0.02),
            "w_i": _w((lambda *s: torch.randn(*s, dtype=torch.bfloat16) * 0.05)(S, Df) * 0.02),
        }
    _A_in = _A_setup()

    def _B_setup():
        B, S, Dm, Df = 1, 2048, 512, 1792
        return {
            "x": _w((lambda *s: torch.randn(*s, dtype=torch.bfloat16) * 0.05)(B, S, Dm)),
            "w_gate": _w((lambda *s: torch.randn(*s, dtype=torch.bfloat16) * 0.2)(Dm, Df) * (Dm ** -0.5)),
            "w_up": _w((lambda *s: torch.randn(*s, dtype=torch.bfloat16) * 0.2)(Dm, Df) * (Dm ** -0.5)),
            "w_down": _w((lambda *s: torch.randn(*s, dtype=torch.bfloat16) * 0.2)(Df, Dm) * (Df ** -0.5)),
        }
    _B_in = _B_setup()

    return {
        "A_x": _A_in["x"],
        "A_w_r": _A_in["w_r"],
        "A_w_i": _A_in["w_i"],
        "B_x": _B_in["x"],
        "B_w_gate": _B_in["w_gate"],
        "B_w_up": _B_in["w_up"],
        "B_w_down": _B_in["w_down"],
        "gate_w": _w((lambda *s: torch.randn(*s, dtype=torch.bfloat16) * 0.05)(512) * 16.0),
    }

def reference(A_x, A_w_r, A_w_i, B_x, B_w_gate, B_w_up, B_w_down, gate_w):
    def _A_ref(x, w_r, w_i):
        B, S, D = x.shape
        X = (lambda x, axes=(-2,-1): torch.fft.rfft2(x.float(), dim=axes))(x, axes=(-2, -1))
        W = w_r + 1j * w_i
        X = X * W
        y = (lambda x, s, axes=(-2,-1): torch.fft.irfft2(x, s=s, dim=axes).to(torch.bfloat16))(X, (S, D), axes=(-2, -1))
        return y

    def _B_ref(x, w_gate, w_up, w_down):
        g = torch.einsum("bsd,df->bsf", x, w_gate)
        u = torch.einsum("bsd,df->bsf", x, w_up)
        h = _gelu(g) * u
        return torch.einsum("bsf,fd->bsd", h, w_down)

    x = A_x
    g = _sigmoid((x * gate_w).sum(-1, keepdims=True))
    a = _A_ref(x, A_w_r, A_w_i)
    b = _B_ref(x, B_w_gate, B_w_up, B_w_down)
    return g * a + (1 - g) * b
```

```asm
; @launch grid=(256,1,1) block=(512,1,1) lds=163840
.amdgcn_target "amdgcn-amd-amdhsa--gfx950"
.text
.globl gated_mix__spectral_gfnet__glu_gated_geglu__prompt_kernel
.p2align 8
.type gated_mix__spectral_gfnet__glu_gated_geglu__prompt_kernel,@function
gated_mix__spectral_gfnet__glu_gated_geglu__prompt_kernel:
PK_START:
    s_cmp_ge_u32 s2, 256
    s_cbranch_scc1 PK_END
    s_load_dwordx4 s[4:7], s[0:1], 0
    s_load_dwordx4 s[12:15], s[0:1], 32
    s_load_dwordx2 s[8:9], s[0:1], 16
    s_load_dwordx4 s[16:19], s[0:1], 48
    s_load_dwordx4 s[20:23], s[0:1], 64
    s_load_dwordx2 s[36:37], s[0:1], 80
    v_lshrrev_b32 v16, 6, v0
    v_and_b32 v1, 63, v0
    s_and_b32 s10, s2, 1
    s_lshl_b32 s10, s10, 2
    s_bfe_u32 s11, s2, 0x20003
    s_add_u32 s56, s10, s11
    v_readfirstlane_b32 s58, v16
    s_bfe_u32 s10, s2, 0x20001
    s_lshr_b32 s59, s2, 5
    s_mul_i32 s11, s10, 7
    s_add_u32 s11, s11, s59
    s_sub_u32 s57, s11, 1
    s_lshl_b32 s11, s56, 2
    s_add_u32 s73, s11, s10
    v_lshrrev_b32 v16, 4, v1
    v_lshrrev_b32 v17, 3, v1
    v_and_b32 v18, 7, v1
    v_xor_b32 v18, v18, v16
    v_lshlrev_b32 v18, 4, v18
    v_lshl_add_u32 v3, v17, 10, v18
    v_xor_b32 v4, 64, v3
    s_mov_b32 s26, 2097152
    s_mov_b32 s27, 0x20000
    s_cmp_eq_u32 s59, 0
    s_cbranch_scc1 PK_FFT
    s_lshl_b32 s10, s56, 1
    s_add_u32 s10, s10, s59
    s_mul_i32 s10, s10, 1
    s_add_u32 s61, s10, s58
    s_and_b32 s61, s61, 7
    s_lshr_b32 s10, s56, 2
    s_lshl_b32 s10, s10, 14
    s_and_b32 s11, s56, 3
    s_lshl_b32 s11, s11, 19
    s_add_u32 s10, s10, s11
    s_lshl_b32 s11, s61, 16
    s_add_u32 s64, s10, s11
    s_add_u32 s65, s64, 8192
    s_add_u32 s66, s64, 32768
    s_add_u32 s67, s64, 40960
    s_lshl_b32 s10, s61, 12
    s_add_u32 s68, s10, 49152
    s_lshl_b32 s69, s61, 10
    s_lshl_b32 s10, s61, 3
    v_add_u32 v20, s10, v17
    v_mul_u32_u24 v20, 3584, v20
    v_bfe_u32 v18, v1, 1, 2
    v_and_b32 v21, 1, v16
    v_xor_b32 v18, v18, v21
    s_and_b32 s10, s61, 1
    s_lshl_b32 s10, s10, 1
    v_xor_b32 v18, s10, v18
    v_lshlrev_b32 v18, 5, v18
    v_and_b32 v19, 1, v1
    v_lshl_add_u32 v18, v19, 4, v18
    v_add_u32 v5, v20, v18
    s_lshl_b32 s60, s57, 7
    s_add_u32 s10, s59, s56
    s_and_b32 s10, s10, 0
    s_lshl_b32 s11, s10, 7
    v_xor_b32 v190, 128, v3
    v_xor_b32 v190, s11, v190
    v_xor_b32 v191, 64, v190
    v_xor_b32 v3, s11, v3
    v_xor_b32 v4, s11, v4
    s_mul_i32 s11, s10, 229376
    s_add_u32 s60, s60, s11
    s_lshl_b32 s11, s11, 1
    s_sub_u32 s74, 229376, s11
    s_add_u32 s75, s11, 229376
    s_mov_b32 s30, 1835008
    s_mov_b32 s31, 0x20000
    s_mov_b32 s34, 1835008
    s_mov_b32 s35, 0x20000
    s_waitcnt lgkmcnt(0)
    s_mov_b32 s24, s4
    s_mov_b32 s25, s5
    s_mov_b32 s28, s12
    s_mov_b32 s29, s13
    s_mov_b32 s32, s14
    s_mov_b32 s33, s15
    s_add_u32 m0, s69, 0
    s_nop 0
    buffer_load_dwordx4 v5, s[28:31], s60 offen lds
    s_add_u32 m0, s69, 8192
    s_nop 0
    buffer_load_dwordx4 v5, s[32:35], s60 offen lds
    s_add_u32 s60, s60, s74
    s_add_u32 m0, s68, 0
    s_nop 0
    buffer_load_dwordx4 v3, s[24:27], s64 offen offset:0 lds
    s_add_u32 m0, s68, 1024
    s_nop 0
    buffer_load_dwordx4 v4, s[24:27], s65 offen offset:0 lds
    s_add_u32 m0, s68, 2048
    s_nop 0
    buffer_load_dwordx4 v3, s[24:27], s66 offen offset:0 lds
    s_add_u32 m0, s68, 3072
    s_nop 0
    buffer_load_dwordx4 v4, s[24:27], s67 offen offset:0 lds
    s_add_u32 s0, s36, 15593472
    s_addc_u32 s1, s37, 0
    s_load_dword s22, s[0:1], 0
    s_mov_b32 s38, 16777216
    s_mov_b32 s39, 0x20000
    v_lshlrev_b32 v2, 4, v1
    v_mov_b32 v15, 0
    s_mov_b32 s48, s16
    s_mov_b32 s49, s17
    s_mov_b32 s50, 1835008
    s_mov_b32 s51, 0x20000
    s_and_b32 s80, s58, 3
    s_mov_b32 s70, 0x05040100
    s_mov_b32 s71, 0x07060302
    v_bfe_u32 v18, v1, 1, 2
    v_xor_b32 v20, v18, v16
    v_lshlrev_b32 v20, 5, v20
    v_and_b32 v19, 1, v1
    v_lshl_add_u32 v20, v19, 4, v20
    v_lshl_add_u32 v14, v17, 10, v20
    v_lshlrev_b32 v12, 7, v1
    s_mov_b32 s101, 15663104
    s_mov_b32 s100, 0
    s_and_b32 s10, s2, 7
    s_lshl_b32 s10, s10, 2
    s_bfe_u32 s11, s2, 0x20003
    s_add_u32 s78, s10, s11
    s_xor_b32 s79, s59, 3
    s_lshr_b32 s10, s58, 1
    s_mul_i32 s10, s10, 458752
    s_and_b32 s3, s58, 1
    s_lshl_b32 s3, s3, 14
    s_add_u32 s10, s10, s3
    s_lshl_b32 s11, s79, 7
    s_add_u32 s81, s10, s11
    s_lshl_b32 s83, s58, 11
    s_mul_i32 s10, s80, 458752
    s_add_u32 s82, s10, s11
    s_lshl_b32 s72, s80, 12
    s_add_u32 s10, s79, s78
    s_and_b32 s12, s10, 0
    s_lshl_b32 s10, s12, 15
    s_sub_u32 s13, s81, s10
    s_add_u32 s81, s81, s10
    s_sub_u32 s14, s82, s10
    s_add_u32 s82, s82, s10
    s_mov_b32 s38, 16777216
    s_mov_b32 s39, 0x20000
    v_lshlrev_b32 v2, 4, v1
    s_mov_b32 s40, s6
    s_mov_b32 s41, s7
    s_mov_b32 s42, 1052672
    s_mov_b32 s43, 0x20000
    s_mov_b32 s44, s8
    s_mov_b32 s45, s9
    s_mov_b32 s46, 1052672
    s_mov_b32 s47, 0x20000
    s_lshr_b32 s10, s2, 6
    s_lshl_b32 s10, s10, 4
    s_add_u32 s10, s10, s58
    s_and_b32 s11, s2, 4
    s_lshl_b32 s11, s11, 1
    s_add_u32 s10, s10, s11
    s_and_b32 s11, s2, 0x38
    s_lshl_b32 s11, s11, 5
    s_add_u32 s10, s10, s11
    s_mul_i32 s10, s10, 514
    s_andn2_b32 s10, s10, 3
    s_and_b32 s63, s2, 3
    s_lshl_b32 s11, s63, 7
    s_add_u32 s6, s10, s11
    s_mul_i32 s62, s58, 1168
    s_add_u32 s62, s62, 147456
    v_mul_u32_u24 v18, 57, v1
    v_lshrrev_b32 v18, 9, v18
    v_mul_u32_u24 v18, 32752, v18
    v_add_u32 v184, v18, v2
    v_and_b32 v18, 7, v1
    v_mul_u32_u24 v19, 1168, v18
    v_and_b32 v20, 1, v1
    v_add_u32 v20, v20, v17
    v_lshl_add_u32 v19, v20, 1, v19
    s_lshl_b32 s10, s58, 4
    s_add_u32 s10, s10, 147456
    v_add_u32 v185, s10, v19
    v_lshlrev_b32 v18, 4, v18
    v_lshl_add_u32 v186, v17, 13, v18
    s_lshr_b32 s4, s2, 2
    s_lshl_b32 s4, s4, 7
    s_lshl_b32 s10, s2, 7
    s_add_u32 s76, s10, 15597568
    s_lshl_b32 s10, s63, 19
    s_lshl_b32 s11, s58, 16
    s_add_u32 s10, s10, s11
    s_add_u32 s7, s10, s4
    s_add_u32 s7, s7, 11534336
    s_add_u32 s5, s4, 13631488
    s_lshl_b32 s10, s56, 5
    s_add_u32 s10, s10, s57
    s_lshl_b32 s10, s10, 7
    s_add_u32 s77, s10, 15630336
    v_and_b32 v21, 15, v1
    v_bfe_u32 v18, v1, 1, 3
    v_xor_b32 v18, v16, v18
    v_lshlrev_b32 v18, 4, v18
    v_lshl_add_u32 v18, v21, 7, v18
    s_lshr_b32 s10, s58, 1
    s_lshl_b32 s10, s10, 13
    s_add_u32 s10, s10, 49152
    v_add_u32 v6, s10, v18
    v_xor_b32 v7, 64, v6
    v_add_u32 v8, 0x10000, v6
    v_add_u32 v9, 0x10000, v7
    v_bfe_u32 v18, v1, 2, 2
    v_lshl_add_u32 v20, v16, 3, v18
    v_lshlrev_b32 v20, 7, v20
    v_bfe_u32 v19, v1, 3, 2
    s_and_b32 s10, s58, 1
    s_lshl_b32 s10, s10, 1
    v_xor_b32 v19, s10, v19
    v_lshl_add_u32 v20, v19, 5, v20
    v_and_b32 v19, 3, v1
    v_lshl_add_u32 v10, v19, 3, v20
    v_xor_b32 v11, 32, v10
    s_and_b32 s9, s78, 3
    s_mul_i32 s9, s9, 458752
    s_lshl_b32 s11, s79, 7
    s_add_u32 s9, s9, s11
    v_lshlrev_b32 v203, 10, v1
    v_lshl_add_u32 v16, v1, 2, 0
    v_add_u32 v16, 163776, v16
    v_mov_b32 v18, 0
    s_mov_b64 exec, 0xff
    ds_write_b32 v16, v18
    s_mov_b64 exec, -1
    s_add_u32 m0, s69, 16384
    s_nop 0
    buffer_load_dwordx4 v5, s[28:31], s60 offen lds
    s_add_u32 m0, s69, 24576
    s_nop 0
    buffer_load_dwordx4 v5, s[32:35], s60 offen lds
    s_add_u32 s60, s60, s75
    s_add_u32 m0, s68, 32768
    s_nop 0
    buffer_load_dwordx4 v190, s[24:27], s64 offen offset:0 lds
    s_add_u32 m0, s68, 33792
    s_nop 0
    buffer_load_dwordx4 v191, s[24:27], s65 offen offset:0 lds
    s_add_u32 m0, s68, 34816
    s_nop 0
    buffer_load_dwordx4 v190, s[24:27], s66 offen offset:0 lds
    s_add_u32 m0, s68, 35840
    s_nop 0
    buffer_load_dwordx4 v191, s[24:27], s67 offen offset:0 lds
    s_cmp_ge_u32 s58, 4
    s_cbranch_scc1 PK_NBC
    v_and_b32 v16, 15, v1
    v_lshrrev_b32 v17, 4, v1
    v_lshlrev_b32 v17, 2, v17
    s_lshl_b32 s10, s80, 4
    v_add_u32 v20, s10, v16
    v_add_u32 v21, s10, v17
    v_cvt_f32_u32 v16, v16
    v_cvt_f32_u32 v17, v17
    v_cvt_f32_u32 v20, v20
    v_cvt_f32_u32 v21, v21
    v_mul_f32 v18, 0x3c800000, v20
    v_mul_f32 v19, v18, v17
    v_mov_b32 v216, v19
    v_fmamk_f32 v217, v18, 0x3f800000, v19
    v_fmamk_f32 v218, v18, 0x40000000, v19
    v_fmamk_f32 v219, v18, 0x40400000, v19
    v_sin_f32 v220, v216
    v_sin_f32 v221, v217
    v_sin_f32 v222, v218
    v_sin_f32 v223, v219
    v_cos_f32 v216, v216
    v_cos_f32 v217, v217
    v_cos_f32 v218, v218
    v_cos_f32 v219, v219
    v_cvt_pk_bf16_f32 v208, v216, v220
    v_cvt_pk_bf16_f32 v209, v217, v221
    v_cvt_pk_bf16_f32 v210, v218, v222
    v_cvt_pk_bf16_f32 v211, v219, v223
    v_cvt_pk_bf16_f32 v192, -v220, v216
    v_cvt_pk_bf16_f32 v193, -v221, v217
    v_cvt_pk_bf16_f32 v194, -v222, v218
    v_cvt_pk_bf16_f32 v195, -v223, v219
    v_fmamk_f32 v216, v18, 0x41800000, v19
    v_fmamk_f32 v217, v18, 0x41880000, v19
    v_fmamk_f32 v218, v18, 0x41900000, v19
    v_fmamk_f32 v219, v18, 0x41980000, v19
    v_sin_f32 v220, v216
    v_sin_f32 v221, v217
    v_sin_f32 v222, v218
    v_sin_f32 v223, v219
    v_cos_f32 v216, v216
    v_cos_f32 v217, v217
    v_cos_f32 v218, v218
    v_cos_f32 v219, v219
    v_cvt_pk_bf16_f32 v212, v216, v220
    v_cvt_pk_bf16_f32 v213, v217, v221
    v_cvt_pk_bf16_f32 v214, v218, v222
    v_cvt_pk_bf16_f32 v215, v219, v223
    v_cvt_pk_bf16_f32 v196, -v220, v216
    v_cvt_pk_bf16_f32 v197, -v221, v217
    v_cvt_pk_bf16_f32 v198, -v222, v218
    v_cvt_pk_bf16_f32 v199, -v223, v219
    v_mul_f32 v18, 0x3a000000, v20
    v_mul_f32 v19, v18, v17
    v_mov_b32 v224, v19
    v_fmamk_f32 v225, v18, 0x3f800000, v19
    v_fmamk_f32 v226, v18, 0x40000000, v19
    v_fmamk_f32 v227, v18, 0x40400000, v19
    v_fmamk_f32 v228, v18, 0x41800000, v19
    v_fmamk_f32 v229, v18, 0x41880000, v19
    v_fmamk_f32 v230, v18, 0x41900000, v19
    v_fmamk_f32 v231, v18, 0x41980000, v19
    v_sin_f32 v232, v224
    v_sin_f32 v233, v225
    v_sin_f32 v234, v226
    v_sin_f32 v235, v227
    v_sin_f32 v236, v228
    v_sin_f32 v237, v229
    v_sin_f32 v238, v230
    v_sin_f32 v239, v231
    v_cos_f32 v224, v224
    v_cos_f32 v225, v225
    v_cos_f32 v226, v226
    v_cos_f32 v227, v227
    v_cos_f32 v228, v228
    v_cos_f32 v229, v229
    v_cos_f32 v230, v230
    v_cos_f32 v231, v231
    v_mul_f32 v18, 0x3d000000, v16
    v_mul_f32 v19, v18, v17
    v_mov_b32 v216, v19
    v_fmamk_f32 v217, v18, 0x3f800000, v19
    v_fmamk_f32 v218, v18, 0x40000000, v19
    v_fmamk_f32 v219, v18, 0x40400000, v19
    v_sin_f32 v220, v216
    v_sin_f32 v221, v217
    v_sin_f32 v222, v218
    v_sin_f32 v223, v219
    v_cos_f32 v216, v216
    v_cos_f32 v217, v217
    v_cos_f32 v218, v218
    v_cos_f32 v219, v219
    v_cvt_pk_bf16_f32 v176, v216, v220
    v_cvt_pk_bf16_f32 v177, v217, v221
    v_cvt_pk_bf16_f32 v178, v218, v222
    v_cvt_pk_bf16_f32 v179, v219, v223
    v_cvt_pk_bf16_f32 v160, -v220, v216
    v_cvt_pk_bf16_f32 v161, -v221, v217
    v_cvt_pk_bf16_f32 v162, -v222, v218
    v_cvt_pk_bf16_f32 v163, -v223, v219
    v_mul_f32 v18, 0x3a000000, v16
    v_mul_f32 v19, v18, v21
    v_mov_b32 v240, v19
    v_fmamk_f32 v241, v18, 0x3f800000, v19
    v_fmamk_f32 v242, v18, 0x40000000, v19
    v_fmamk_f32 v243, v18, 0x40400000, v19
    v_add_f32 v18, 0x3c000000, v18
    v_mul_f32 v19, v18, v21
    v_mov_b32 v244, v19
    v_fmamk_f32 v245, v18, 0x3f800000, v19
    v_fmamk_f32 v246, v18, 0x40000000, v19
    v_fmamk_f32 v247, v18, 0x40400000, v19
    v_sin_f32 v248, v240
    v_sin_f32 v249, v241
    v_sin_f32 v250, v242
    v_sin_f32 v251, v243
    v_sin_f32 v252, v244
    v_sin_f32 v253, v245
    v_sin_f32 v254, v246
    v_sin_f32 v255, v247
    v_cos_f32 v240, v240
    v_cos_f32 v241, v241
    v_cos_f32 v242, v242
    v_cos_f32 v243, v243
    v_cos_f32 v244, v244
    v_cos_f32 v245, v245
    v_cos_f32 v246, v246
    v_cos_f32 v247, v247
    s_nop 0
    s_branch PK_NBD
PK_NBC:
    v_lshrrev_b32 v252, 2, v1
    v_lshlrev_b32 v252, 7, v252
    v_bfe_u32 v253, v1, 3, 2
    v_lshl_add_u32 v252, v253, 5, v252
    v_and_b32 v253, 3, v1
    v_lshl_add_u32 v252, v253, 3, v252
    v_add_u32 v252, s72, v252
    s_lshl_b32 s10, s80, 5
    v_xor_b32 v251, s10, v252
    s_add_u32 s11, s10, 32
    s_and_b32 s11, s11, 96
    v_xor_b32 v248, s11, v252
    v_xor_b32 v249, 64, v251
    v_xor_b32 v250, 64, v248
    v_add_u32 v252, 81920, v248
    v_add_u32 v253, 81920, v249
    v_add_u32 v254, 81920, v250
    v_add_u32 v255, 81920, v251
PK_NBD:
    s_waitcnt lgkmcnt(0)
    s_add_u32 s22, s22, 1
    s_xor_b32 s23, s22, 0x9e3779b9
    s_waitcnt vmcnt(6)
    s_barrier
    ds_read_b64_tr_b16 v[40:41], v10 offset:0
    ds_read_b64_tr_b16 v[42:43], v10 offset:512
    ds_read_b128 v[24:27], v6 offset:0
    ds_read_b128 v[28:31], v6 offset:2048
    ds_read_b64_tr_b16 v[44:45], v11 offset:0
    ds_read_b64_tr_b16 v[46:47], v11 offset:512
    ds_read_b128 v[32:35], v6 offset:4096
    ds_read_b128 v[36:39], v6 offset:6144
    ds_read_b64_tr_b16 v[48:49], v10 offset:8192
    ds_read_b64_tr_b16 v[50:51], v10 offset:8704
    ds_read_b64_tr_b16 v[52:53], v11 offset:8192
    ds_read_b64_tr_b16 v[54:55], v11 offset:8704
    s_and_b32 s10, s58, 6
    s_cmp_lg_u32 s10, 4
    s_cbranch_scc1 PK_NMTB
    s_sub_u32 s10, s56, 2
    s_cmp_ge_u32 s10, 1
    s_cbranch_scc1 PK_NMTB
    s_mul_i32 s10, s56, 229376
    s_lshl_b32 s11, s57, 7
    s_add_u32 s10, s10, s11
    v_mul_u32_u24 v13, 3584, v1
    s_cmp_eq_u32 s58, 5
    s_cbranch_scc1 PK_MTUB
    buffer_load_dword v13, v13, s[28:31], s10 offen
    s_branch PK_NMTB
PK_MTUB:
    buffer_load_dword v13, v13, s[32:35], s10 offen
PK_NMTB:
    s_waitcnt lgkmcnt(0)
    v_mfma_f32_16x16x32_bf16 v[88:91], v[40:43], v[24:27], 0
    ds_read_b64_tr_b16 v[72:73], v10 offset:4096
    ds_read_b64_tr_b16 v[74:75], v10 offset:4608
    v_mfma_f32_16x16x32_bf16 v[92:95], v[40:43], v[28:31], 0
    ds_read_b128 v[56:59], v7 offset:0
    ds_read_b128 v[60:63], v7 offset:2048
    v_mfma_f32_16x16x32_bf16 v[104:107], v[44:47], v[24:27], 0
    ds_read_b64_tr_b16 v[76:77], v11 offset:4096
    ds_read_b64_tr_b16 v[78:79], v11 offset:4608
    s_add_u32 m0, s69, 32768
    v_mfma_f32_16x16x32_bf16 v[108:111], v[44:47], v[28:31], 0
    buffer_load_dwordx4 v5, s[28:31], s60 offen lds
    v_mfma_f32_16x16x32_bf16 v[96:99], v[40:43], v[32:35], 0
    ds_read_b128 v[64:67], v7 offset:4096
    ds_read_b128 v[68:71], v7 offset:6144
    v_mfma_f32_16x16x32_bf16 v[112:115], v[44:47], v[32:35], 0
    ds_read_b64_tr_b16 v[80:81], v10 offset:12288
    ds_read_b64_tr_b16 v[82:83], v10 offset:12800
    v_mfma_f32_16x16x32_bf16 v[100:103], v[40:43], v[36:39], 0
    ds_read_b64_tr_b16 v[84:85], v11 offset:12288
    s_add_u32 m0, s69, 40960
    v_mfma_f32_16x16x32_bf16 v[116:119], v[44:47], v[36:39], 0
    buffer_load_dwordx4 v5, s[32:35], s60 offen lds
    s_add_u32 s60, s60, s74
    v_mfma_f32_16x16x32_bf16 v[120:123], v[48:51], v[24:27], 0
    ds_read_b64_tr_b16 v[86:87], v11 offset:12800
    v_mfma_f32_16x16x32_bf16 v[124:127], v[48:51], v[28:31], 0
    s_and_b32 s10, s58, 6
    s_cmp_lg_u32 s10, 4
    s_cbranch_scc1 PK_NMTC3
    s_sub_u32 s10, s56, 3
    s_cmp_ge_u32 s10, 1
    s_cbranch_scc1 PK_NMTC3
    s_mul_i32 s10, s56, 229376
    s_lshl_b32 s11, s57, 7
    s_add_u32 s10, s10, s11
    v_mul_u32_u24 v13, 3584, v1
    s_cmp_eq_u32 s58, 5
    s_cbranch_scc1 PK_MTUC3
    buffer_load_dword v13, v13, s[28:31], s10 offen
    s_branch PK_NMTC3
PK_MTUC3:
    buffer_load_dword v13, v13, s[32:35], s10 offen
PK_NMTC3:
    v_mfma_f32_16x16x32_bf16 v[128:131], v[48:51], v[32:35], 0
    s_and_b32 s10, s58, 6
    s_cmp_lg_u32 s10, 4
    s_cbranch_scc1 PK_NMTC4
    s_sub_u32 s10, s56, 4
    s_cmp_ge_u32 s10, 1
    s_cbranch_scc1 PK_NMTC4
    s_mul_i32 s10, s56, 229376
    s_lshl_b32 s11, s57, 7
    s_add_u32 s10, s10, s11
    v_mul_u32_u24 v13, 3584, v1
    s_cmp_eq_u32 s58, 5
    s_cbranch_scc1 PK_MTUC4
    buffer_load_dword v13, v13, s[28:31], s10 offen
    s_branch PK_NMTC4
PK_MTUC4:
    buffer_load_dword v13, v13, s[32:35], s10 offen
PK_NMTC4:
    s_add_u32 m0, s68, 65280
    v_mfma_f32_16x16x32_bf16 v[132:135], v[48:51], v[36:39], 0
    buffer_load_dwordx4 v3, s[24:27], s64 offen offset:256 lds
    v_mfma_f32_16x16x32_bf16 v[136:139], v[52:55], v[24:27], 0
    v_mfma_f32_16x16x32_bf16 v[140:143], v[52:55], v[28:31], 0
    s_add_u32 m0, s68, 66304
    v_mfma_f32_16x16x32_bf16 v[144:147], v[52:55], v[32:35], 0
    buffer_load_dwordx4 v4, s[24:27], s65 offen offset:256 lds
    v_mfma_f32_16x16x32_bf16 v[148:151], v[52:55], v[36:39], 0
    s_waitcnt lgkmcnt(0)
    s_waitcnt vmcnt(4)
    s_barrier
    s_setprio 3
    v_mfma_f32_16x16x32_bf16 v[88:91], v[72:75], v[56:59], v[88:91]
    ds_read_b64_tr_b16 v[40:41], v10 offset:16384
    ds_read_b64_tr_b16 v[42:43], v10 offset:16896
    v_mfma_f32_16x16x32_bf16 v[92:95], v[72:75], v[60:63], v[92:95]
    ds_read_b128 v[24:27], v6 offset:32768
    ds_read_b128 v[28:31], v6 offset:34816
    v_mfma_f32_16x16x32_bf16 v[104:107], v[76:79], v[56:59], v[104:107]
    ds_read_b64_tr_b16 v[44:45], v11 offset:16384
    ds_read_b64_tr_b16 v[46:47], v11 offset:16896
    s_add_u32 m0, s68, 67328
    v_mfma_f32_16x16x32_bf16 v[108:111], v[76:79], v[60:63], v[108:111]
    buffer_load_dwordx4 v3, s[24:27], s66 offen offset:256 lds
    v_mfma_f32_16x16x32_bf16 v[96:99], v[72:75], v[64:67], v[96:99]
    ds_read_b128 v[32:35], v6 offset:36864
    ds_read_b128 v[36:39], v6 offset:38912
    v_mfma_f32_16x16x32_bf16 v[112:115], v[76:79], v[64:67], v[112:115]
    ds_read_b64_tr_b16 v[48:49], v10 offset:24576
    ds_read_b64_tr_b16 v[50:51], v10 offset:25088
    v_mfma_f32_16x16x32_bf16 v[100:103], v[72:75], v[68:71], v[100:103]
    ds_read_b64_tr_b16 v[52:53], v11 offset:24576
    s_add_u32 m0, s68, 68352
    v_mfma_f32_16x16x32_bf16 v[116:119], v[76:79], v[68:71], v[116:119]
    buffer_load_dwordx4 v4, s[24:27], s67 offen offset:256 lds
    s_setprio 2
    v_mfma_f32_16x16x32_bf16 v[120:123], v[80:83], v[56:59], v[120:123]
    ds_read_b64_tr_b16 v[54:55], v11 offset:25088
    v_mfma_f32_16x16x32_bf16 v[124:127], v[80:83], v[60:63], v[124:127]
    s_and_b32 s10, s58, 6
    s_cmp_lg_u32 s10, 4
    s_cbranch_scc1 PK_NMTC5
    s_sub_u32 s10, s56, 5
    s_cmp_ge_u32 s10, 1
    s_cbranch_scc1 PK_NMTC5
    s_mul_i32 s10, s56, 229376
    s_lshl_b32 s11, s57, 7
    s_add_u32 s10, s10, s11
    v_mul_u32_u24 v13, 3584, v1
    s_cmp_eq_u32 s58, 5
    s_cbranch_scc1 PK_MTUC5
    buffer_load_dword v13, v13, s[28:31], s10 offen
    s_branch PK_NMTC5
PK_MTUC5:
    buffer_load_dword v13, v13, s[32:35], s10 offen
PK_NMTC5:
    v_mfma_f32_16x16x32_bf16 v[128:131], v[80:83], v[64:67], v[128:131]
    s_add_u32 m0, s69, 0
    v_mfma_f32_16x16x32_bf16 v[132:135], v[80:83], v[68:71], v[132:135]
    buffer_load_dwordx4 v5, s[28:31], s60 offen lds
    v_mfma_f32_16x16x32_bf16 v[136:139], v[84:87], v[56:59], v[136:139]
    v_mfma_f32_16x16x32_bf16 v[140:143], v[84:87], v[60:63], v[140:143]
    s_add_u32 m0, s69, 8192
    v_mfma_f32_16x16x32_bf16 v[144:147], v[84:87], v[64:67], v[144:147]
    buffer_load_dwordx4 v5, s[32:35], s60 offen lds
    s_add_u32 s60, s60, s75
    v_mfma_f32_16x16x32_bf16 v[148:151], v[84:87], v[68:71], v[148:151]
    s_waitcnt lgkmcnt(0)
    s_setprio 1
    v_mfma_f32_16x16x32_bf16 v[88:91], v[40:43], v[24:27], v[88:91]
    ds_read_b64_tr_b16 v[72:73], v10 offset:20480
    ds_read_b64_tr_b16 v[74:75], v10 offset:20992
    v_mfma_f32_16x16x32_bf16 v[92:95], v[40:43], v[28:31], v[92:95]
    ds_read_b128 v[56:59], v7 offset:32768
    ds_read_b128 v[60:63], v7 offset:34816
    v_mfma_f32_16x16x32_bf16 v[104:107], v[44:47], v[24:27], v[104:107]
    ds_read_b64_tr_b16 v[76:77], v11 offset:20480
    ds_read_b64_tr_b16 v[78:79], v11 offset:20992
    s_sub_u32 m0, s68, 256
    v_mfma_f32_16x16x32_bf16 v[108:111], v[44:47], v[28:31], v[108:111]
    buffer_load_dwordx4 v190, s[24:27], s64 offen offset:256 lds
    v_mfma_f32_16x16x32_bf16 v[96:99], v[40:43], v[32:35], v[96:99]
    ds_read_b128 v[64:67], v7 offset:36864
    ds_read_b128 v[68:71], v7 offset:38912
    v_mfma_f32_16x16x32_bf16 v[112:115], v[44:47], v[32:35], v[112:115]
    ds_read_b64_tr_b16 v[80:81], v10 offset:28672
    ds_read_b64_tr_b16 v[82:83], v10 offset:29184
    v_mfma_f32_16x16x32_bf16 v[100:103], v[40:43], v[36:39], v[100:103]
    ds_read_b64_tr_b16 v[84:85], v11 offset:28672
    s_add_u32 m0, s68, 768
    v_mfma_f32_16x16x32_bf16 v[116:119], v[44:47], v[36:39], v[116:119]
    buffer_load_dwordx4 v191, s[24:27], s65 offen offset:256 lds
    s_setprio 0
    v_mfma_f32_16x16x32_bf16 v[120:123], v[48:51], v[24:27], v[120:123]
    ds_read_b64_tr_b16 v[86:87], v11 offset:29184
    v_mfma_f32_16x16x32_bf16 v[124:127], v[48:51], v[28:31], v[124:127]
    s_add_u32 m0, s62, 0
    s_mov_b32 exec_hi, 15
    buffer_load_dwordx4 v184, s[40:43], s6 offen lds
    s_mov_b32 exec_hi, -1
    v_mfma_f32_16x16x32_bf16 v[128:131], v[48:51], v[32:35], v[128:131]
    s_add_u32 m0, s68, 1792
    v_mfma_f32_16x16x32_bf16 v[132:135], v[48:51], v[36:39], v[132:135]
    buffer_load_dwordx4 v190, s[24:27], s66 offen offset:256 lds
    v_mfma_f32_16x16x32_bf16 v[136:139], v[52:55], v[24:27], v[136:139]
    s_add_u32 m0, s62, 576
    s_mov_b32 exec_hi, 15
    buffer_load_dwordx4 v184, s[44:47], s6 offen lds
    s_mov_b32 exec_hi, -1
    v_mfma_f32_16x16x32_bf16 v[140:143], v[52:55], v[28:31], v[140:143]
    s_add_u32 m0, s68, 2816
    v_mfma_f32_16x16x32_bf16 v[144:147], v[52:55], v[32:35], v[144:147]
    buffer_load_dwordx4 v191, s[24:27], s67 offen offset:256 lds
    v_mfma_f32_16x16x32_bf16 v[148:151], v[52:55], v[36:39], v[148:151]
    s_waitcnt lgkmcnt(0)
    s_waitcnt vmcnt(8)
    s_barrier
    s_setprio 3
    v_mfma_f32_16x16x32_bf16 v[88:91], v[72:75], v[56:59], v[88:91]
    ds_read_b64_tr_b16 v[40:41], v10 offset:32768
    ds_read_b64_tr_b16 v[42:43], v10 offset:33280
    v_mfma_f32_16x16x32_bf16 v[92:95], v[72:75], v[60:63], v[92:95]
    ds_read_b128 v[24:27], v8 offset:0
    ds_read_b128 v[28:31], v8 offset:2048
    v_mfma_f32_16x16x32_bf16 v[104:107], v[76:79], v[56:59], v[104:107]
    ds_read_b64_tr_b16 v[44:45], v11 offset:32768
    ds_read_b64_tr_b16 v[46:47], v11 offset:33280
    s_add_u32 m0, s69, 16384
    v_mfma_f32_16x16x32_bf16 v[108:111], v[76:79], v[60:63], v[108:111]
    buffer_load_dwordx4 v5, s[28:31], s60 offen lds
    v_mfma_f32_16x16x32_bf16 v[96:99], v[72:75], v[64:67], v[96:99]
    ds_read_b128 v[32:35], v8 offset:4096
    ds_read_b128 v[36:39], v8 offset:6144
    v_mfma_f32_16x16x32_bf16 v[112:115], v[76:79], v[64:67], v[112:115]
    ds_read_b64_tr_b16 v[48:49], v10 offset:40960
    ds_read_b64_tr_b16 v[50:51], v10 offset:41472
    v_mfma_f32_16x16x32_bf16 v[100:103], v[72:75], v[68:71], v[100:103]
    ds_read_b64_tr_b16 v[52:53], v11 offset:40960
    v_mfma_f32_16x16x32_bf16 v[116:119], v[76:79], v[68:71], v[116:119]
    ds_read_b64_tr_b16 v[54:55], v11 offset:41472
    s_setprio 2
    s_add_u32 m0, s69, 24576
    v_mfma_f32_16x16x32_bf16 v[120:123], v[80:83], v[56:59], v[120:123]
    buffer_load_dwordx4 v5, s[32:35], s60 offen lds
    s_add_u32 s60, s60, s74
    v_mfma_f32_16x16x32_bf16 v[124:127], v[80:83], v[60:63], v[124:127]
    s_and_b32 s10, s58, 6
    s_cmp_lg_u32 s10, 4
    s_cbranch_scc1 PK_NMTC6
    s_sub_u32 s10, s56, 6
    s_cmp_ge_u32 s10, 1
    s_cbranch_scc1 PK_NMTC6
    s_mul_i32 s10, s56, 229376
    s_lshl_b32 s11, s57, 7
    s_add_u32 s10, s10, s11
    v_mul_u32_u24 v13, 3584, v1
    s_cmp_eq_u32 s58, 5
    s_cbranch_scc1 PK_MTUC6
    buffer_load_dword v13, v13, s[28:31], s10 offen
    s_branch PK_NMTC6
PK_MTUC6:
    buffer_load_dword v13, v13, s[32:35], s10 offen
PK_NMTC6:
    v_mfma_f32_16x16x32_bf16 v[128:131], v[80:83], v[64:67], v[128:131]
    v_mfma_f32_16x16x32_bf16 v[132:135], v[80:83], v[68:71], v[132:135]
    v_mfma_f32_16x16x32_bf16 v[136:139], v[84:87], v[56:59], v[136:139]
    s_add_u32 m0, s68, 32256
    v_mfma_f32_16x16x32_bf16 v[140:143], v[84:87], v[60:63], v[140:143]
    buffer_load_dwordx4 v3, s[24:27], s64 offen offset:512 lds
    v_mfma_f32_16x16x32_bf16 v[144:147], v[84:87], v[64:67], v[144:147]
    v_mfma_f32_16x16x32_bf16 v[148:151], v[84:87], v[68:71], v[148:151]
    s_waitcnt lgkmcnt(0)
    s_setprio 1
    v_mfma_f32_16x16x32_bf16 v[88:91], v[40:43], v[24:27], v[88:91]
    ds_read_b64_tr_b16 v[72:73], v10 offset:36864
    ds_read_b64_tr_b16 v[74:75], v10 offset:37376
    v_mfma_f32_16x16x32_bf16 v[92:95], v[40:43], v[28:31], v[92:95]
    ds_read_b128 v[56:59], v9 offset:0
    ds_read_b128 v[60:63], v9 offset:2048
    v_mfma_f32_16x16x32_bf16 v[104:107], v[44:47], v[24:27], v[104:107]
    ds_read_b64_tr_b16 v[76:77], v11 offset:36864
    ds_read_b64_tr_b16 v[78:79], v11 offset:37376
    s_add_u32 m0, s68, 33280
    v_mfma_f32_16x16x32_bf16 v[108:111], v[44:47], v[28:31], v[108:111]
    buffer_load_dwordx4 v4, s[24:27], s65 offen offset:512 lds
    v_mfma_f32_16x16x32_bf16 v[96:99], v[40:43], v[32:35], v[96:99]
    ds_read_b128 v[64:67], v9 offset:4096
    ds_read_b128 v[68:71], v9 offset:6144
    v_mfma_f32_16x16x32_bf16 v[112:115], v[44:47], v[32:35], v[112:115]
    ds_read_b64_tr_b16 v[80:81], v10 offset:45056
    ds_read_b64_tr_b16 v[82:83], v10 offset:45568
    v_mfma_f32_16x16x32_bf16 v[100:103], v[40:43], v[36:39], v[100:103]
    ds_read_b64_tr_b16 v[84:85], v11 offset:45056
    v_mfma_f32_16x16x32_bf16 v[116:119], v[44:47], v[36:39], v[116:119]
    ds_read_b64_tr_b16 v[86:87], v11 offset:45568
    s_setprio 0
    s_add_u32 m0, s68, 34304
    v_mfma_f32_16x16x32_bf16 v[120:123], v[48:51], v[24:27], v[120:123]
    buffer_load_dwordx4 v3, s[24:27], s66 offen offset:512 lds
    v_mfma_f32_16x16x32_bf16 v[124:127], v[48:51], v[28:31], v[124:127]
    v_mfma_f32_16x16x32_bf16 v[128:131], v[48:51], v[32:35], v[128:131]
    v_mfma_f32_16x16x32_bf16 v[132:135], v[48:51], v[36:39], v[132:135]
    v_mfma_f32_16x16x32_bf16 v[136:139], v[52:55], v[24:27], v[136:139]
    s_add_u32 m0, s68, 35328
    v_mfma_f32_16x16x32_bf16 v[140:143], v[52:55], v[28:31], v[140:143]
    buffer_load_dwordx4 v4, s[24:27], s67 offen offset:512 lds
    v_mfma_f32_16x16x32_bf16 v[144:147], v[52:55], v[32:35], v[144:147]
    v_mfma_f32_16x16x32_bf16 v[148:151], v[52:55], v[36:39], v[148:151]
    s_waitcnt lgkmcnt(0)
    s_waitcnt vmcnt(6)
    s_barrier
    s_setprio 3
    v_mfma_f32_16x16x32_bf16 v[88:91], v[72:75], v[56:59], v[88:91]
    ds_read_b64_tr_b16 v[40:41], v10 offset:0
    ds_read_b64_tr_b16 v[42:43], v10 offset:512
    v_mfma_f32_16x16x32_bf16 v[92:95], v[72:75], v[60:63], v[92:95]
    ds_read_b128 v[24:27], v6 offset:0
    ds_read_b128 v[28:31], v6 offset:2048
    v_mfma_f32_16x16x32_bf16 v[104:107], v[76:79], v[56:59], v[104:107]
    ds_read_b64_tr_b16 v[44:45], v11 offset:0
    ds_read_b64_tr_b16 v[46:47], v11 offset:512
    s_add_u32 m0, s69, 32768
    v_mfma_f32_16x16x32_bf16 v[108:111], v[76:79], v[60:63], v[108:111]
    buffer_load_dwordx4 v5, s[28:31], s60 offen lds
    v_mfma_f32_16x16x32_bf16 v[96:99], v[72:75], v[64:67], v[96:99]
    ds_read_b128 v[32:35], v6 offset:4096
    ds_read_b128 v[36:39], v6 offset:6144
    v_mfma_f32_16x16x32_bf16 v[112:115], v[76:79], v[64:67], v[112:115]
    ds_read_b64_tr_b16 v[48:49], v10 offset:8192
    ds_read_b64_tr_b16 v[50:51], v10 offset:8704
    v_mfma_f32_16x16x32_bf16 v[100:103], v[72:75], v[68:71], v[100:103]
    ds_read_b64_tr_b16 v[52:53], v11 offset:8192
    v_mfma_f32_16x16x32_bf16 v[116:119], v[76:79], v[68:71], v[116:119]
    ds_read_b64_tr_b16 v[54:55], v11 offset:8704
    s_setprio 2
    s_add_u32 m0, s69, 40960
    v_mfma_f32_16x16x32_bf16 v[120:123], v[80:83], v[56:59], v[120:123]
    buffer_load_dwordx4 v5, s[32:35], s60 offen lds
    s_add_u32 s60, s60, s75
    ds_read_u16 v164, v185 offset:0
    ds_read_u16 v168, v185 offset:576
    v_mfma_f32_16x16x32_bf16 v[124:127], v[80:83], v[60:63], v[124:127]
    s_and_b32 s10, s58, 6
    s_cmp_lg_u32 s10, 4
    s_cbranch_scc1 PK_NMTC7
    s_sub_u32 s10, s56, 7
    s_cmp_ge_u32 s10, 1
    s_cbranch_scc1 PK_NMTC7
    s_mul_i32 s10, s56, 229376
    s_lshl_b32 s11, s57, 7
    s_add_u32 s10, s10, s11
    v_mul_u32_u24 v13, 3584, v1
    s_cmp_eq_u32 s58, 5
    s_cbranch_scc1 PK_MTUC7
    buffer_load_dword v13, v13, s[28:31], s10 offen
    s_branch PK_NMTC7
PK_MTUC7:
    buffer_load_dword v13, v13, s[32:35], s10 offen
PK_NMTC7:
    ds_read_u16 v165, v185 offset:144
    s_waitcnt lgkmcnt(14)
    ds_read_u16 v169, v185 offset:720
    v_mfma_f32_16x16x32_bf16 v[128:131], v[80:83], v[64:67], v[128:131]
    s_waitcnt lgkmcnt(14)
    ds_read_u16 v166, v185 offset:288
    s_waitcnt lgkmcnt(14)
    ds_read_u16 v170, v185 offset:864
    v_mfma_f32_16x16x32_bf16 v[132:135], v[80:83], v[68:71], v[132:135]
    s_waitcnt lgkmcnt(14)
    ds_read_u16 v167, v185 offset:432
    s_waitcnt lgkmcnt(14)
    ds_read_u16 v171, v185 offset:1008
    v_mfma_f32_16x16x32_bf16 v[136:139], v[84:87], v[56:59], v[136:139]
    s_add_u32 m0, s68, 65024
    v_mfma_f32_16x16x32_bf16 v[140:143], v[84:87], v[60:63], v[140:143]
    buffer_load_dwordx4 v190, s[24:27], s64 offen offset:512 lds
    v_mfma_f32_16x16x32_bf16 v[144:147], v[84:87], v[64:67], v[144:147]
    v_mfma_f32_16x16x32_bf16 v[148:151], v[84:87], v[68:71], v[148:151]
    s_waitcnt lgkmcnt(0)
    s_setprio 1
    v_mfma_f32_16x16x32_bf16 v[88:91], v[40:43], v[24:27], v[88:91]
    ds_read_b64_tr_b16 v[72:73], v10 offset:4096
    ds_read_b64_tr_b16 v[74:75], v10 offset:4608
    v_mfma_f32_16x16x32_bf16 v[92:95], v[40:43], v[28:31], v[92:95]
    ds_read_b128 v[56:59], v7 offset:0
    ds_read_b128 v[60:63], v7 offset:2048
    v_mfma_f32_16x16x32_bf16 v[104:107], v[44:47], v[24:27], v[104:107]
    ds_read_b64_tr_b16 v[76:77], v11 offset:4096
    ds_read_b64_tr_b16 v[78:79], v11 offset:4608
    s_add_u32 m0, s68, 66048
    v_mfma_f32_16x16x32_bf16 v[108:111], v[44:47], v[28:31], v[108:111]
    buffer_load_dwordx4 v191, s[24:27], s65 offen offset:512 lds
    v_mfma_f32_16x16x32_bf16 v[96:99], v[40:43], v[32:35], v[96:99]
    ds_read_b128 v[64:67], v7 offset:4096
    ds_read_b128 v[68:71], v7 offset:6144
    v_mfma_f32_16x16x32_bf16 v[112:115], v[44:47], v[32:35], v[112:115]
    ds_read_b64_tr_b16 v[80:81], v10 offset:12288
    ds_read_b64_tr_b16 v[82:83], v10 offset:12800
    v_mfma_f32_16x16x32_bf16 v[100:103], v[40:43], v[36:39], v[100:103]
    ds_read_b64_tr_b16 v[84:85], v11 offset:12288
    v_mfma_f32_16x16x32_bf16 v[116:119], v[44:47], v[36:39], v[116:119]
    ds_read_b64_tr_b16 v[86:87], v11 offset:12800
    s_setprio 0
    s_add_u32 m0, s68, 67072
    v_mfma_f32_16x16x32_bf16 v[120:123], v[48:51], v[24:27], v[120:123]
    buffer_load_dwordx4 v190, s[24:27], s66 offen offset:512 lds
    v_mfma_f32_16x16x32_bf16 v[124:127], v[48:51], v[28:31], v[124:127]
    v_lshl_or_b32 v164, v168, 16, v164
    v_lshl_or_b32 v165, v169, 16, v165
    v_lshl_or_b32 v166, v170, 16, v166
    v_lshl_or_b32 v167, v171, 16, v167
    v_mfma_f32_16x16x32_bf16 v[128:131], v[48:51], v[32:35], v[128:131]
    s_lshl_b32 s10, s58, 2
    s_add_u32 s10, s10, s63
    s_cmp_lg_u32 s10, 3
    s_cbranch_scc1 PK_NOA2SF
    v_lshrrev_b32 v172, 2, v1
    v_and_b32 v173, 1, v172
    v_mul_u32_u24 v172, 1168, v172
    v_lshl_add_u32 v172, v173, 1, v172
    v_and_b32 v173, 3, v1
    v_mul_u32_u24 v173, 144, v173
    v_add_u32 v172, v172, v173
    v_add_u32 v172, 147584, v172
    v_lshlrev_b32 v174, 2, v1
    s_mov_b32 exec_hi, 0
    ds_read_u16 v173, v172 offset:576
    ds_read_u16 v172, v172
    s_waitcnt lgkmcnt(0)
    v_lshl_or_b32 v172, v173, 16, v172
    buffer_store_dword v172, v174, s[36:39], s5 offen sc1
    s_mov_b32 exec_hi, -1
PK_NOA2SF:
    v_mfma_f32_16x16x32_bf16 v[132:135], v[48:51], v[36:39], v[132:135]
    buffer_store_dwordx4 v[164:167], v186, s[36:39], s7 offen sc1
    v_mfma_f32_16x16x32_bf16 v[136:139], v[52:55], v[24:27], v[136:139]
    s_add_u32 m0, s68, 68096
    v_mfma_f32_16x16x32_bf16 v[140:143], v[52:55], v[28:31], v[140:143]
    buffer_load_dwordx4 v191, s[24:27], s67 offen offset:512 lds
    v_mfma_f32_16x16x32_bf16 v[144:147], v[52:55], v[32:35], v[144:147]
    v_mfma_f32_16x16x32_bf16 v[148:151], v[52:55], v[36:39], v[148:151]
    s_waitcnt lgkmcnt(0)
    s_waitcnt vmcnt(7)
    s_barrier
    s_setprio 3
    v_mfma_f32_16x16x32_bf16 v[88:91], v[72:75], v[56:59], v[88:91]
    ds_read_b64_tr_b16 v[40:41], v10 offset:16384
    ds_read_b64_tr_b16 v[42:43], v10 offset:16896
    v_mfma_f32_16x16x32_bf16 v[92:95], v[72:75], v[60:63], v[92:95]
    ds_read_b128 v[24:27], v6 offset:32768
    ds_read_b128 v[28:31], v6 offset:34816
    v_mfma_f32_16x16x32_bf16 v[104:107], v[76:79], v[56:59], v[104:107]
    ds_read_b64_tr_b16 v[44:45], v11 offset:16384
    ds_read_b64_tr_b16 v[46:47], v11 offset:16896
    s_add_u32 m0, s69, 0
    v_mfma_f32_16x16x32_bf16 v[108:111], v[76:79], v[60:63], v[108:111]
    buffer_load_dwordx4 v5, s[28:31], s60 offen lds
    v_mfma_f32_16x16x32_bf16 v[96:99], v[72:75], v[64:67], v[96:99]
    ds_read_b128 v[32:35], v6 offset:36864
    ds_read_b128 v[36:39], v6 offset:38912
    v_mfma_f32_16x16x32_bf16 v[112:115], v[76:79], v[64:67], v[112:115]
    ds_read_b64_tr_b16 v[48:49], v10 offset:24576
    ds_read_b64_tr_b16 v[50:51], v10 offset:25088
    v_mfma_f32_16x16x32_bf16 v[100:103], v[72:75], v[68:71], v[100:103]
    ds_read_b64_tr_b16 v[52:53], v11 offset:24576
    v_mfma_f32_16x16x32_bf16 v[116:119], v[76:79], v[68:71], v[116:119]
    ds_read_b64_tr_b16 v[54:55], v11 offset:25088
    s_setprio 2
    s_add_u32 m0, s69, 8192
    v_mfma_f32_16x16x32_bf16 v[120:123], v[80:83], v[56:59], v[120:123]
    buffer_load_dwordx4 v5, s[32:35], s60 offen lds
    s_add_u32 s60, s60, s74
    v_mfma_f32_16x16x32_bf16 v[124:127], v[80:83], v[60:63], v[124:127]
    v_mfma_f32_16x16x32_bf16 v[128:131], v[80:83], v[64:67], v[128:131]
    v_mfma_f32_16x16x32_bf16 v[132:135], v[80:83], v[68:71], v[132:135]
    v_mfma_f32_16x16x32_bf16 v[136:139], v[84:87], v[56:59], v[136:139]
    s_sub_u32 m0, s68, 768
    v_mfma_f32_16x16x32_bf16 v[140:143], v[84:87], v[60:63], v[140:143]
    buffer_load_dwordx4 v3, s[24:27], s64 offen offset:768 lds
    v_mfma_f32_16x16x32_bf16 v[144:147], v[84:87], v[64:67], v[144:147]
    v_mfma_f32_16x16x32_bf16 v[148:151], v[84:87], v[68:71], v[148:151]
    s_waitcnt lgkmcnt(0)
    s_setprio 1
    v_mfma_f32_16x16x32_bf16 v[88:91], v[40:43], v[24:27], v[88:91]
    ds_read_b64_tr_b16 v[72:73], v10 offset:20480
    ds_read_b64_tr_b16 v[74:75], v10 offset:20992
    v_mfma_f32_16x16x32_bf16 v[92:95], v[40:43], v[28:31], v[92:95]
    ds_read_b128 v[56:59], v7 offset:32768
    ds_read_b128 v[60:63], v7 offset:34816
    v_mfma_f32_16x16x32_bf16 v[104:107], v[44:47], v[24:27], v[104:107]
    ds_read_b64_tr_b16 v[76:77], v11 offset:20480
    ds_read_b64_tr_b16 v[78:79], v11 offset:20992
    s_add_u32 m0, s68, 256
    v_mfma_f32_16x16x32_bf16 v[108:111], v[44:47], v[28:31], v[108:111]
    buffer_load_dwordx4 v4, s[24:27], s65 offen offset:768 lds
    v_mfma_f32_16x16x32_bf16 v[96:99], v[40:43], v[32:35], v[96:99]
    ds_read_b128 v[64:67], v7 offset:36864
    ds_read_b128 v[68:71], v7 offset:38912
    v_mfma_f32_16x16x32_bf16 v[112:115], v[44:47], v[32:35], v[112:115]
    ds_read_b64_tr_b16 v[80:81], v10 offset:28672
    ds_read_b64_tr_b16 v[82:83], v10 offset:29184
    v_mfma_f32_16x16x32_bf16 v[100:103], v[40:43], v[36:39], v[100:103]
    ds_read_b64_tr_b16 v[84:85], v11 offset:28672
    v_mfma_f32_16x16x32_bf16 v[116:119], v[44:47], v[36:39], v[116:119]
    ds_read_b64_tr_b16 v[86:87], v11 offset:29184
    s_setprio 0
    s_add_u32 m0, s68, 1280
    v_mfma_f32_16x16x32_bf16 v[120:123], v[48:51], v[24:27], v[120:123]
    buffer_load_dwordx4 v3, s[24:27], s66 offen offset:768 lds
    v_mfma_f32_16x16x32_bf16 v[124:127], v[48:51], v[28:31], v[124:127]
    v_mfma_f32_16x16x32_bf16 v[128:131], v[48:51], v[32:35], v[128:131]
    v_mfma_f32_16x16x32_bf16 v[132:135], v[48:51], v[36:39], v[132:135]
    v_mfma_f32_16x16x32_bf16 v[136:139], v[52:55], v[24:27], v[136:139]
    s_add_u32 m0, s68, 2304
    v_mfma_f32_16x16x32_bf16 v[140:143], v[52:55], v[28:31], v[140:143]
    buffer_load_dwordx4 v4, s[24:27], s67 offen offset:768 lds
    v_mfma_f32_16x16x32_bf16 v[144:147], v[52:55], v[32:35], v[144:147]
    v_mfma_f32_16x16x32_bf16 v[148:151], v[52:55], v[36:39], v[148:151]
    s_waitcnt lgkmcnt(0)
    s_waitcnt vmcnt(6)
    s_barrier
    s_setprio 3
    v_mfma_f32_16x16x32_bf16 v[88:91], v[72:75], v[56:59], v[88:91]
    ds_read_b64_tr_b16 v[40:41], v10 offset:32768
    ds_read_b64_tr_b16 v[42:43], v10 offset:33280
    v_mfma_f32_16x16x32_bf16 v[92:95], v[72:75], v[60:63], v[92:95]
    ds_read_b128 v[24:27], v8 offset:0
    ds_read_b128 v[28:31], v8 offset:2048
    v_mfma_f32_16x16x32_bf16 v[104:107], v[76:79], v[56:59], v[104:107]
    ds_read_b64_tr_b16 v[44:45], v11 offset:32768
    ds_read_b64_tr_b16 v[46:47], v11 offset:33280
    s_add_u32 m0, s69, 16384
    v_mfma_f32_16x16x32_bf16 v[108:111], v[76:79], v[60:63], v[108:111]
    buffer_load_dwordx4 v5, s[28:31], s60 offen lds
    v_mfma_f32_16x16x32_bf16 v[96:99], v[72:75], v[64:67], v[96:99]
    ds_read_b128 v[32:35], v8 offset:4096
    ds_read_b128 v[36:39], v8 offset:6144
    v_mfma_f32_16x16x32_bf16 v[112:115], v[76:79], v[64:67], v[112:115]
    ds_read_b64_tr_b16 v[48:49], v10 offset:40960
    ds_read_b64_tr_b16 v[50:51], v10 offset:41472
    v_mfma_f32_16x16x32_bf16 v[100:103], v[72:75], v[68:71], v[100:103]
    ds_read_b64_tr_b16 v[52:53], v11 offset:40960
    v_mfma_f32_16x16x32_bf16 v[116:119], v[76:79], v[68:71], v[116:119]
    ds_read_b64_tr_b16 v[54:55], v11 offset:41472
    s_setprio 2
    s_add_u32 m0, s69, 24576
    v_mfma_f32_16x16x32_bf16 v[120:123], v[80:83], v[56:59], v[120:123]
    buffer_load_dwordx4 v5, s[32:35], s60 offen lds
    s_add_u32 s60, s60, s75
    v_mfma_f32_16x16x32_bf16 v[124:127], v[80:83], v[60:63], v[124:127]
    s_cmp_lg_u32 s58, 0
    s_cbranch_scc1 PK_NFF
    s_mov_b64 exec, 0xff
    v_mov_b32 v164, s22
    v_mov_b32 v165, s23
    v_mov_b32 v166, s22
    v_mov_b32 v167, s23
    buffer_store_dwordx4 v[164:167], v2, s[36:39], s76 offen sc1
    s_mov_b64 exec, -1
    s_nop 0
PK_NFF:
    v_mfma_f32_16x16x32_bf16 v[128:131], v[80:83], v[64:67], v[128:131]
    v_mfma_f32_16x16x32_bf16 v[132:135], v[80:83], v[68:71], v[132:135]
    v_mfma_f32_16x16x32_bf16 v[136:139], v[84:87], v[56:59], v[136:139]
    s_add_u32 m0, s68, 32000
    v_mfma_f32_16x16x32_bf16 v[140:143], v[84:87], v[60:63], v[140:143]
    buffer_load_dwordx4 v190, s[24:27], s64 offen offset:768 lds
    v_mfma_f32_16x16x32_bf16 v[144:147], v[84:87], v[64:67], v[144:147]
    v_mfma_f32_16x16x32_bf16 v[148:151], v[84:87], v[68:71], v[148:151]
    s_waitcnt lgkmcnt(0)
    s_setprio 1
    v_mfma_f32_16x16x32_bf16 v[88:91], v[40:43], v[24:27], v[88:91]
    ds_read_b64_tr_b16 v[72:73], v10 offset:36864
    ds_read_b64_tr_b16 v[74:75], v10 offset:37376
    v_mfma_f32_16x16x32_bf16 v[92:95], v[40:43], v[28:31], v[92:95]
    ds_read_b128 v[56:59], v9 offset:0
    ds_read_b128 v[60:63], v9 offset:2048
    v_mfma_f32_16x16x32_bf16 v[104:107], v[44:47], v[24:27], v[104:107]
    ds_read_b64_tr_b16 v[76:77], v11 offset:36864
    ds_read_b64_tr_b16 v[78:79], v11 offset:37376
    s_add_u32 m0, s68, 33024
    v_mfma_f32_16x16x32_bf16 v[108:111], v[44:47], v[28:31], v[108:111]
    buffer_load_dwordx4 v191, s[24:27], s65 offen offset:768 lds
    v_mfma_f32_16x16x32_bf16 v[96:99], v[40:43], v[32:35], v[96:99]
    ds_read_b128 v[64:67], v9 offset:4096
    ds_read_b128 v[68:71], v9 offset:6144
    v_mfma_f32_16x16x32_bf16 v[112:115], v[44:47], v[32:35], v[112:115]
    ds_read_b64_tr_b16 v[80:81], v10 offset:45056
    ds_read_b64_tr_b16 v[82:83], v10 offset:45568
    v_mfma_f32_16x16x32_bf16 v[100:103], v[40:43], v[36:39], v[100:103]
    ds_read_b64_tr_b16 v[84:85], v11 offset:45056
    v_mfma_f32_16x16x32_bf16 v[116:119], v[44:47], v[36:39], v[116:119]
    ds_read_b64_tr_b16 v[86:87], v11 offset:45568
    s_setprio 0
    s_add_u32 m0, s68, 34048
    v_mfma_f32_16x16x32_bf16 v[120:123], v[48:51], v[24:27], v[120:123]
    buffer_load_dwordx4 v190, s[24:27], s66 offen offset:768 lds
    v_mfma_f32_16x16x32_bf16 v[124:127], v[48:51], v[28:31], v[124:127]
    v_mfma_f32_16x16x32_bf16 v[128:131], v[48:51], v[32:35], v[128:131]
    v_mfma_f32_16x16x32_bf16 v[132:135], v[48:51], v[36:39], v[132:135]
    v_mfma_f32_16x16x32_bf16 v[136:139], v[52:55], v[24:27], v[136:139]
    s_add_u32 m0, s68, 35072
    v_mfma_f32_16x16x32_bf16 v[140:143], v[52:55], v[28:31], v[140:143]
    buffer_load_dwordx4 v191, s[24:27], s67 offen offset:768 lds
    v_mfma_f32_16x16x32_bf16 v[144:147], v[52:55], v[32:35], v[144:147]
    v_mfma_f32_16x16x32_bf16 v[148:151], v[52:55], v[36:39], v[148:151]
    s_waitcnt lgkmcnt(0)
    s_waitcnt vmcnt(6)
    s_barrier
    s_setprio 3
    v_mfma_f32_16x16x32_bf16 v[88:91], v[72:75], v[56:59], v[88:91]
    ds_read_b64_tr_b16 v[40:41], v10 offset:0
    ds_read_b64_tr_b16 v[42:43], v10 offset:512
    v_mfma_f32_16x16x32_bf16 v[92:95], v[72:75], v[60:63], v[92:95]
    ds_read_b128 v[24:27], v6 offset:0
    ds_read_b128 v[28:31], v6 offset:2048
    v_mfma_f32_16x16x32_bf16 v[104:107], v[76:79], v[56:59], v[104:107]
    ds_read_b64_tr_b16 v[44:45], v11 offset:0
    ds_read_b64_tr_b16 v[46:47], v11 offset:512
    v_mfma_f32_16x16x32_bf16 v[108:111], v[76:79], v[60:63], v[108:111]
    s_add_u32 m0, s83, 114688
    s_add_u32 s61, s81, 0
    buffer_load_dwordx4 v14, s[48:51], s61 offen lds
    v_mfma_f32_16x16x32_bf16 v[96:99], v[72:75], v[64:67], v[96:99]
    ds_read_b128 v[32:35], v6 offset:4096
    ds_read_b128 v[36:39], v6 offset:6144
    v_mfma_f32_16x16x32_bf16 v[112:115], v[76:79], v[64:67], v[112:115]
    ds_read_b64_tr_b16 v[48:49], v10 offset:8192
    ds_read_b64_tr_b16 v[50:51], v10 offset:8704
    v_mfma_f32_16x16x32_bf16 v[100:103], v[72:75], v[68:71], v[100:103]
    ds_read_b64_tr_b16 v[52:53], v11 offset:8192
    v_mfma_f32_16x16x32_bf16 v[116:119], v[76:79], v[68:71], v[116:119]
    ds_read_b64_tr_b16 v[54:55], v11 offset:8704
    s_setprio 2
    v_mfma_f32_16x16x32_bf16 v[120:123], v[80:83], v[56:59], v[120:123]
    s_add_u32 m0, s83, 115712
    s_add_u32 s61, s81, 8192
    buffer_load_dwordx4 v14, s[48:51], s61 offen lds
    v_mfma_f32_16x16x32_bf16 v[124:127], v[80:83], v[60:63], v[124:127]
    v_mfma_f32_16x16x32_bf16 v[128:131], v[80:83], v[64:67], v[128:131]
    v_mfma_f32_16x16x32_bf16 v[132:135], v[80:83], v[68:71], v[132:135]
    v_mfma_f32_16x16x32_bf16 v[136:139], v[84:87], v[56:59], v[136:139]
    v_mfma_f32_16x16x32_bf16 v[140:143], v[84:87], v[60:63], v[140:143]
    s_add_u32 m0, s83, 131072
    s_add_u32 s61, s13, 32768
    buffer_load_dwordx4 v14, s[48:51], s61 offen lds
    v_mfma_f32_16x16x32_bf16 v[144:147], v[84:87], v[64:67], v[144:147]
    v_mfma_f32_16x16x32_bf16 v[148:151], v[84:87], v[68:71], v[148:151]
    s_waitcnt lgkmcnt(0)
    s_setprio 1
    v_mfma_f32_16x16x32_bf16 v[88:91], v[40:43], v[24:27], v[88:91]
    ds_read_b64_tr_b16 v[72:73], v10 offset:4096
    ds_read_b64_tr_b16 v[74:75], v10 offset:4608
    v_mfma_f32_16x16x32_bf16 v[92:95], v[40:43], v[28:31], v[92:95]
    ds_read_b128 v[56:59], v7 offset:0
    ds_read_b128 v[60:63], v7 offset:2048
    v_mfma_f32_16x16x32_bf16 v[104:107], v[44:47], v[24:27], v[104:107]
    ds_read_b64_tr_b16 v[76:77], v11 offset:4096
    ds_read_b64_tr_b16 v[78:79], v11 offset:4608
    v_mfma_f32_16x16x32_bf16 v[108:111], v[44:47], v[28:31], v[108:111]
    s_add_u32 m0, s83, 132096
    s_add_u32 s61, s13, 40960
    buffer_load_dwordx4 v14, s[48:51], s61 offen lds
    v_mfma_f32_16x16x32_bf16 v[96:99], v[40:43], v[32:35], v[96:99]
    ds_read_b128 v[64:67], v7 offset:4096
    ds_read_b128 v[68:71], v7 offset:6144
    v_mfma_f32_16x16x32_bf16 v[112:115], v[44:47], v[32:35], v[112:115]
    ds_read_b64_tr_b16 v[80:81], v10 offset:12288
    ds_read_b64_tr_b16 v[82:83], v10 offset:12800
    v_mfma_f32_16x16x32_bf16 v[100:103], v[40:43], v[36:39], v[100:103]
    ds_read_b64_tr_b16 v[84:85], v11 offset:12288
    v_mfma_f32_16x16x32_bf16 v[116:119], v[44:47], v[36:39], v[116:119]
    ds_read_b64_tr_b16 v[86:87], v11 offset:12800
    s_setprio 0
    v_mfma_f32_16x16x32_bf16 v[120:123], v[48:51], v[24:27], v[120:123]
    s_add_u32 m0, s83, 32768
    s_add_u32 s61, s81, 65536
    buffer_load_dwordx4 v14, s[48:51], s61 offen lds
    v_mfma_f32_16x16x32_bf16 v[124:127], v[48:51], v[28:31], v[124:127]
    v_mfma_f32_16x16x32_bf16 v[128:131], v[48:51], v[32:35], v[128:131]
    v_mfma_f32_16x16x32_bf16 v[132:135], v[48:51], v[36:39], v[132:135]
    v_mfma_f32_16x16x32_bf16 v[136:139], v[52:55], v[24:27], v[136:139]
    v_mfma_f32_16x16x32_bf16 v[140:143], v[52:55], v[28:31], v[140:143]
    s_add_u32 m0, s83, 33792
    s_add_u32 s61, s81, 73728
    buffer_load_dwordx4 v14, s[48:51], s61 offen lds
    v_mfma_f32_16x16x32_bf16 v[144:147], v[52:55], v[32:35], v[144:147]
    v_mfma_f32_16x16x32_bf16 v[148:151], v[52:55], v[36:39], v[148:151]
    s_waitcnt lgkmcnt(0)
    s_waitcnt vmcnt(6)
    s_barrier
    s_setprio 3
    v_mfma_f32_16x16x32_bf16 v[88:91], v[72:75], v[56:59], v[88:91]
    ds_read_b64_tr_b16 v[40:41], v10 offset:16384
    ds_read_b64_tr_b16 v[42:43], v10 offset:16896
    v_mfma_f32_16x16x32_bf16 v[92:95], v[72:75], v[60:63], v[92:95]
    ds_read_b128 v[24:27], v6 offset:32768
    ds_read_b128 v[28:31], v6 offset:34816
    v_mfma_f32_16x16x32_bf16 v[104:107], v[76:79], v[56:59], v[104:107]
    ds_read_b64_tr_b16 v[44:45], v11 offset:16384
    ds_read_b64_tr_b16 v[46:47], v11 offset:16896
    v_mfma_f32_16x16x32_bf16 v[108:111], v[76:79], v[60:63], v[108:111]
    s_add_u32 m0, s83, 0
    s_add_u32 s61, s13, 98304
    buffer_load_dwordx4 v14, s[48:51], s61 offen lds
    v_mfma_f32_16x16x32_bf16 v[96:99], v[72:75], v[64:67], v[96:99]
    ds_read_b128 v[32:35], v6 offset:36864
    ds_read_b128 v[36:39], v6 offset:38912
    v_mfma_f32_16x16x32_bf16 v[112:115], v[76:79], v[64:67], v[112:115]
    ds_read_b64_tr_b16 v[48:49], v10 offset:24576
    ds_read_b64_tr_b16 v[50:51], v10 offset:25088
    v_mfma_f32_16x16x32_bf16 v[100:103], v[72:75], v[68:71], v[100:103]
    ds_read_b64_tr_b16 v[52:53], v11 offset:24576
    v_mfma_f32_16x16x32_bf16 v[116:119], v[76:79], v[68:71], v[116:119]
    ds_read_b64_tr_b16 v[54:55], v11 offset:25088
    s_setprio 2
    v_mfma_f32_16x16x32_bf16 v[120:123], v[80:83], v[56:59], v[120:123]
    s_add_u32 m0, s83, 1024
    s_add_u32 s61, s13, 106496
    buffer_load_dwordx4 v14, s[48:51], s61 offen lds
    v_mfma_f32_16x16x32_bf16 v[124:127], v[80:83], v[60:63], v[124:127]
    v_mfma_f32_16x16x32_bf16 v[128:131], v[80:83], v[64:67], v[128:131]
    v_mfma_f32_16x16x32_bf16 v[132:135], v[80:83], v[68:71], v[132:135]
    v_mfma_f32_16x16x32_bf16 v[136:139], v[84:87], v[56:59], v[136:139]
    v_mfma_f32_16x16x32_bf16 v[140:143], v[84:87], v[60:63], v[140:143]
    s_add_u32 m0, s83, 49152
    s_add_u32 s61, s81, 131072
    buffer_load_dwordx4 v14, s[48:51], s61 offen lds
    v_mfma_f32_16x16x32_bf16 v[144:147], v[84:87], v[64:67], v[144:147]
    v_mfma_f32_16x16x32_bf16 v[148:151], v[84:87], v[68:71], v[148:151]
    s_waitcnt lgkmcnt(0)
    s_setprio 1
    v_mfma_f32_16x16x32_bf16 v[88:91], v[40:43], v[24:27], v[88:91]
    ds_read_b64_tr_b16 v[72:73], v10 offset:20480
    ds_read_b64_tr_b16 v[74:75], v10 offset:20992
    v_mfma_f32_16x16x32_bf16 v[92:95], v[40:43], v[28:31], v[92:95]
    ds_read_b128 v[56:59], v7 offset:32768
    ds_read_b128 v[60:63], v7 offset:34816
    v_mfma_f32_16x16x32_bf16 v[104:107], v[44:47], v[24:27], v[104:107]
    ds_read_b64_tr_b16 v[76:77], v11 offset:20480
    ds_read_b64_tr_b16 v[78:79], v11 offset:20992
    v_mfma_f32_16x16x32_bf16 v[108:111], v[44:47], v[28:31], v[108:111]
    s_add_u32 m0, s83, 50176
    s_add_u32 s61, s81, 139264
    buffer_load_dwordx4 v14, s[48:51], s61 offen lds
    v_mfma_f32_16x16x32_bf16 v[96:99], v[40:43], v[32:35], v[96:99]
    ds_read_b128 v[64:67], v7 offset:36864
    ds_read_b128 v[68:71], v7 offset:38912
    v_mfma_f32_16x16x32_bf16 v[112:115], v[44:47], v[32:35], v[112:115]
    ds_read_b64_tr_b16 v[80:81], v10 offset:28672
    ds_read_b64_tr_b16 v[82:83], v10 offset:29184
    v_mfma_f32_16x16x32_bf16 v[100:103], v[40:43], v[36:39], v[100:103]
    ds_read_b64_tr_b16 v[84:85], v11 offset:28672
    v_mfma_f32_16x16x32_bf16 v[116:119], v[44:47], v[36:39], v[116:119]
    ds_read_b64_tr_b16 v[86:87], v11 offset:29184
    s_setprio 0
    v_mfma_f32_16x16x32_bf16 v[120:123], v[48:51], v[24:27], v[120:123]
    s_add_u32 m0, s83, 65536
    s_add_u32 s61, s13, 163840
    buffer_load_dwordx4 v14, s[48:51], s61 offen lds
    v_mfma_f32_16x16x32_bf16 v[124:127], v[48:51], v[28:31], v[124:127]
    v_mfma_f32_16x16x32_bf16 v[128:131], v[48:51], v[32:35], v[128:131]
    v_mfma_f32_16x16x32_bf16 v[132:135], v[48:51], v[36:39], v[132:135]
    v_mfma_f32_16x16x32_bf16 v[136:139], v[52:55], v[24:27], v[136:139]
    v_mfma_f32_16x16x32_bf16 v[140:143], v[52:55], v[28:31], v[140:143]
    s_add_u32 m0, s83, 66560
    s_add_u32 s61, s13, 172032
    buffer_load_dwordx4 v14, s[48:51], s61 offen lds
    v_mfma_f32_16x16x32_bf16 v[144:147], v[52:55], v[32:35], v[144:147]
    v_mfma_f32_16x16x32_bf16 v[148:151], v[52:55], v[36:39], v[148:151]
    s_waitcnt lgkmcnt(0)
    v_mfma_f32_16x16x32_bf16 v[88:91], v[72:75], v[56:59], v[88:91]
    v_mov_b32 v16, 0xc0135761
    v_mov_b32 v17, 0xc0135761
    v_mfma_f32_16x16x32_bf16 v[92:95], v[72:75], v[60:63], v[92:95]
    v_mov_b32 v18, 0xbdd2d3e8
    v_mov_b32 v19, 0xbdd2d3e8
    v_mfma_f32_16x16x32_bf16 v[104:107], v[76:79], v[56:59], v[104:107]
    v_mov_b32 v20, 1.0
    v_mov_b32 v21, 1.0
    v_mfma_f32_16x16x32_bf16 v[108:111], v[76:79], v[60:63], v[108:111]
    s_lshl_b32 s10, s56, 2
    s_lshr_b32 s11, s58, 1
    v_mfma_f32_16x16x32_bf16 v[96:99], v[72:75], v[64:67], v[96:99]
    s_add_u32 s1, s10, s11
    s_mul_i32 s10, s1, 56
    v_mfma_f32_16x16x32_bf16 v[112:115], v[76:79], v[64:67], v[112:115]
    s_lshl_b32 s11, s57, 1
    s_and_b32 s0, s58, 1
    v_mfma_f32_16x16x32_bf16 v[100:103], v[72:75], v[68:71], v[100:103]
    s_add_u32 s11, s11, s0
    s_add_u32 s10, s10, s11
    v_mfma_f32_16x16x32_bf16 v[116:119], v[76:79], v[68:71], v[116:119]
    s_lshl_b32 s10, s10, 12
    v_mfma_f32_16x16x32_bf16 v[120:123], v[80:83], v[56:59], v[120:123]
    v_mfma_f32_16x16x32_bf16 v[124:127], v[80:83], v[60:63], v[124:127]
    v_mfma_f32_16x16x32_bf16 v[128:131], v[80:83], v[64:67], v[128:131]
    v_mfma_f32_16x16x32_bf16 v[132:135], v[80:83], v[68:71], v[132:135]
    v_mfma_f32_16x16x32_bf16 v[136:139], v[84:87], v[56:59], v[136:139]
    v_mfma_f32_16x16x32_bf16 v[140:143], v[84:87], v[60:63], v[140:143]
    v_mfma_f32_16x16x32_bf16 v[144:147], v[84:87], v[64:67], v[144:147]
    v_mfma_f32_16x16x32_bf16 v[148:151], v[84:87], v[68:71], v[148:151]
    v_pk_mul_f32 v[24:25], v[88:89], v[88:89]
    v_pk_mul_f32 v[26:27], v[90:91], v[90:91]
    v_pk_mul_f32 v[28:29], v[104:105], v[104:105]
    v_pk_mul_f32 v[30:31], v[106:107], v[106:107]
    v_pk_fma_f32 v[24:25], v[24:25], v[18:19], v[16:17]
    v_pk_fma_f32 v[26:27], v[26:27], v[18:19], v[16:17]
    v_pk_fma_f32 v[28:29], v[28:29], v[18:19], v[16:17]
    v_pk_fma_f32 v[30:31], v[30:31], v[18:19], v[16:17]
    v_pk_mul_f32 v[24:25], v[24:25], v[88:89]
    v_pk_mul_f32 v[26:27], v[26:27], v[90:91]
    v_pk_mul_f32 v[28:29], v[28:29], v[104:105]
    v_pk_mul_f32 v[30:31], v[30:31], v[106:107]
    v_exp_f32 v24, v24
    v_exp_f32 v25, v25
    v_exp_f32 v26, v26
    v_exp_f32 v27, v27
    v_exp_f32 v28, v28
    v_exp_f32 v29, v29
    v_exp_f32 v30, v30
    v_exp_f32 v31, v31
    v_pk_mul_f32 v[88:89], v[88:89], v[120:121]
    v_pk_mul_f32 v[90:91], v[90:91], v[122:123]
    v_pk_mul_f32 v[104:105], v[104:105], v[136:137]
    v_pk_mul_f32 v[106:107], v[106:107], v[138:139]
    v_pk_add_f32 v[24:25], v[24:25], v[20:21]
    v_pk_add_f32 v[26:27], v[26:27], v[20:21]
    v_pk_add_f32 v[28:29], v[28:29], v[20:21]
    v_pk_add_f32 v[30:31], v[30:31], v[20:21]
    v_rcp_f32 v24, v24
    v_rcp_f32 v25, v25
    v_rcp_f32 v26, v26
    v_rcp_f32 v27, v27
    v_rcp_f32 v28, v28
    v_rcp_f32 v29, v29
    v_rcp_f32 v30, v30
    v_rcp_f32 v31, v31
    v_pk_mul_f32 v[88:89], v[88:89], v[24:25]
    v_pk_mul_f32 v[90:91], v[90:91], v[26:27]
    v_pk_mul_f32 v[104:105], v[104:105], v[28:29]
    v_pk_mul_f32 v[106:107], v[106:107], v[30:31]
    v_cvt_pk_bf16_f32 v32, v88, v89
    v_cvt_pk_bf16_f32 v33, v90, v91
    v_cvt_pk_bf16_f32 v34, v104, v105
    v_cvt_pk_bf16_f32 v35, v106, v107
    buffer_store_dwordx4 v[32:35], v2, s[36:39], s10 offen offset:0 sc1
    v_pk_mul_f32 v[24:25], v[92:93], v[92:93]
    v_pk_mul_f32 v[26:27], v[94:95], v[94:95]
    v_pk_mul_f32 v[28:29], v[108:109], v[108:109]
    v_pk_mul_f32 v[30:31], v[110:111], v[110:111]
    v_pk_fma_f32 v[24:25], v[24:25], v[18:19], v[16:17]
    v_pk_fma_f32 v[26:27], v[26:27], v[18:19], v[16:17]
    v_pk_fma_f32 v[28:29], v[28:29], v[18:19], v[16:17]
    v_pk_fma_f32 v[30:31], v[30:31], v[18:19], v[16:17]
    v_pk_mul_f32 v[24:25], v[24:25], v[92:93]
    v_pk_mul_f32 v[26:27], v[26:27], v[94:95]
    v_pk_mul_f32 v[28:29], v[28:29], v[108:109]
    v_pk_mul_f32 v[30:31], v[30:31], v[110:111]
    v_exp_f32 v24, v24
    v_exp_f32 v25, v25
    v_exp_f32 v26, v26
    v_exp_f32 v27, v27
    v_exp_f32 v28, v28
    v_exp_f32 v29, v29
    v_exp_f32 v30, v30
    v_exp_f32 v31, v31
    v_pk_mul_f32 v[92:93], v[92:93], v[124:125]
    v_pk_mul_f32 v[94:95], v[94:95], v[126:127]
    v_pk_mul_f32 v[108:109], v[108:109], v[140:141]
    v_pk_mul_f32 v[110:111], v[110:111], v[142:143]
    v_pk_add_f32 v[24:25], v[24:25], v[20:21]
    v_pk_add_f32 v[26:27], v[26:27], v[20:21]
    v_pk_add_f32 v[28:29], v[28:29], v[20:21]
    v_pk_add_f32 v[30:31], v[30:31], v[20:21]
    v_rcp_f32 v24, v24
    v_rcp_f32 v25, v25
    v_rcp_f32 v26, v26
    v_rcp_f32 v27, v27
    v_rcp_f32 v28, v28
    v_rcp_f32 v29, v29
    v_rcp_f32 v30, v30
    v_rcp_f32 v31, v31
    v_pk_mul_f32 v[92:93], v[92:93], v[24:25]
    v_pk_mul_f32 v[94:95], v[94:95], v[26:27]
    v_pk_mul_f32 v[108:109], v[108:109], v[28:29]
    v_pk_mul_f32 v[110:111], v[110:111], v[30:31]
    v_cvt_pk_bf16_f32 v36, v92, v93
    v_cvt_pk_bf16_f32 v37, v94, v95
    v_cvt_pk_bf16_f32 v38, v108, v109
    v_cvt_pk_bf16_f32 v39, v110, v111
    buffer_store_dwordx4 v[36:39], v2, s[36:39], s10 offen offset:1024 sc1
    v_pk_mul_f32 v[24:25], v[96:97], v[96:97]
    v_pk_mul_f32 v[26:27], v[98:99], v[98:99]
    v_pk_mul_f32 v[28:29], v[112:113], v[112:113]
    v_pk_mul_f32 v[30:31], v[114:115], v[114:115]
    v_pk_fma_f32 v[24:25], v[24:25], v[18:19], v[16:17]
    v_pk_fma_f32 v[26:27], v[26:27], v[18:19], v[16:17]
    v_pk_fma_f32 v[28:29], v[28:29], v[18:19], v[16:17]
    v_pk_fma_f32 v[30:31], v[30:31], v[18:19], v[16:17]
    v_pk_mul_f32 v[24:25], v[24:25], v[96:97]
    v_pk_mul_f32 v[26:27], v[26:27], v[98:99]
    v_pk_mul_f32 v[28:29], v[28:29], v[112:113]
    v_pk_mul_f32 v[30:31], v[30:31], v[114:115]
    v_exp_f32 v24, v24
    v_exp_f32 v25, v25
    v_exp_f32 v26, v26
    v_exp_f32 v27, v27
    v_exp_f32 v28, v28
    v_exp_f32 v29, v29
    v_exp_f32 v30, v30
    v_exp_f32 v31, v31
    v_pk_mul_f32 v[96:97], v[96:97], v[128:129]
    v_pk_mul_f32 v[98:99], v[98:99], v[130:131]
    v_pk_mul_f32 v[112:113], v[112:113], v[144:145]
    v_pk_mul_f32 v[114:115], v[114:115], v[146:147]
    v_pk_add_f32 v[24:25], v[24:25], v[20:21]
    v_pk_add_f32 v[26:27], v[26:27], v[20:21]
    v_pk_add_f32 v[28:29], v[28:29], v[20:21]
    v_pk_add_f32 v[30:31], v[30:31], v[20:21]
    v_rcp_f32 v24, v24
    v_rcp_f32 v25, v25
    v_rcp_f32 v26, v26
    v_rcp_f32 v27, v27
    v_rcp_f32 v28, v28
    v_rcp_f32 v29, v29
    v_rcp_f32 v30, v30
    v_rcp_f32 v31, v31
    v_pk_mul_f32 v[96:97], v[96:97], v[24:25]
    v_pk_mul_f32 v[98:99], v[98:99], v[26:27]
    v_pk_mul_f32 v[112:113], v[112:113], v[28:29]
    v_pk_mul_f32 v[114:115], v[114:115], v[30:31]
    v_cvt_pk_bf16_f32 v40, v96, v97
    v_cvt_pk_bf16_f32 v41, v98, v99
    v_cvt_pk_bf16_f32 v42, v112, v113
    v_cvt_pk_bf16_f32 v43, v114, v115
    s_cmp_ge_u32 s58, 4
    s_cbranch_scc1 PK_NFL
    s_mov_b32 exec_hi, 0
    buffer_load_dwordx2 v[200:201], v12, s[36:39], s101 offen sc1
    s_mov_b32 exec_hi, -1
PK_NFL:
    buffer_store_dwordx4 v[40:43], v2, s[36:39], s10 offen offset:2048 sc1
    v_pk_mul_f32 v[24:25], v[100:101], v[100:101]
    v_pk_mul_f32 v[26:27], v[102:103], v[102:103]
    v_pk_mul_f32 v[28:29], v[116:117], v[116:117]
    v_pk_mul_f32 v[30:31], v[118:119], v[118:119]
    v_pk_fma_f32 v[24:25], v[24:25], v[18:19], v[16:17]
    v_pk_fma_f32 v[26:27], v[26:27], v[18:19], v[16:17]
    v_pk_fma_f32 v[28:29], v[28:29], v[18:19], v[16:17]
    v_pk_fma_f32 v[30:31], v[30:31], v[18:19], v[16:17]
    v_pk_mul_f32 v[24:25], v[24:25], v[100:101]
    v_pk_mul_f32 v[26:27], v[26:27], v[102:103]
    v_pk_mul_f32 v[28:29], v[28:29], v[116:117]
    v_pk_mul_f32 v[30:31], v[30:31], v[118:119]
    v_exp_f32 v24, v24
    v_exp_f32 v25, v25
    v_exp_f32 v26, v26
    v_exp_f32 v27, v27
    v_exp_f32 v28, v28
    v_exp_f32 v29, v29
    v_exp_f32 v30, v30
    v_exp_f32 v31, v31
    v_pk_mul_f32 v[100:101], v[100:101], v[132:133]
    v_pk_mul_f32 v[102:103], v[102:103], v[134:135]
    v_pk_mul_f32 v[116:117], v[116:117], v[148:149]
    v_pk_mul_f32 v[118:119], v[118:119], v[150:151]
    v_pk_add_f32 v[24:25], v[24:25], v[20:21]
    v_pk_add_f32 v[26:27], v[26:27], v[20:21]
    v_pk_add_f32 v[28:29], v[28:29], v[20:21]
    v_pk_add_f32 v[30:31], v[30:31], v[20:21]
    v_rcp_f32 v24, v24
    v_rcp_f32 v25, v25
    v_rcp_f32 v26, v26
    v_rcp_f32 v27, v27
    v_rcp_f32 v28, v28
    v_rcp_f32 v29, v29
    v_rcp_f32 v30, v30
    v_rcp_f32 v31, v31
    v_pk_mul_f32 v[100:101], v[100:101], v[24:25]
    v_pk_mul_f32 v[102:103], v[102:103], v[26:27]
    v_pk_mul_f32 v[116:117], v[116:117], v[28:29]
    v_pk_mul_f32 v[118:119], v[118:119], v[30:31]
    v_cvt_pk_bf16_f32 v44, v100, v101
    v_cvt_pk_bf16_f32 v45, v102, v103
    v_cvt_pk_bf16_f32 v46, v116, v117
    v_cvt_pk_bf16_f32 v47, v118, v119
    buffer_store_dwordx4 v[44:47], v2, s[36:39], s10 offen offset:3072 sc1
    s_nop 1
    s_branch PK_P2
PK_FFT:
    s_and_b32 s10, s58, 1
    s_lshl_b32 s11, s10, 6
    v_xor_b32 v13, s11, v3
    s_lshl_b32 s11, s10, 3
    s_and_b32 s3, s73, 16
    s_add_u32 s11, s11, s3
    s_and_b32 s3, s73, 15
    s_lshl_b32 s3, s3, 7
    s_add_u32 s11, s11, s3
    s_and_b32 s3, s58, 6
    s_lshl_b32 s3, s3, 4
    s_add_u32 s11, s11, s3
    s_lshl_b32 s74, s11, 10
    s_lshl_b32 s75, s58, 10
    v_bfe_u32 v18, v1, 1, 3
    s_lshl_b32 s10, s58, 3
    v_add_u32 v18, s10, v18
    v_cvt_f32_u32 v18, v18
    v_and_b32 v19, 1, v1
    v_cvt_f32_u32 v19, v19
    v_cvt_f32_u32 v20, v16
    v_mul_f32 v252, 0x3c000000, v18
    v_mul_f32 v253, 0x3e800000, v19
    v_mul_f32 v254, 0x41000000, v20
    v_lshlrev_b32 v2, 4, v1
    s_getpc_b64 s[10:11]
PK_PC:
    s_add_u32 s10, s10, PK_START-PK_PC
    s_addc_u32 s11, s11, -1
    s_and_b32 s3, s56, 3
    s_mul_i32 s3, s3, 10240
    s_mul_i32 s61, s58, 1280
    s_add_u32 s3, s3, s61
    v_lshl_add_u32 v158, v1, 7, s3
    v_min_u32 v158, PK_LAST-PK_START, v158
    v_mov_b32 v159, s11
    v_add_co_u32 v158, vcc, s10, v158
    s_nop 1
    v_addc_co_u32 v159, vcc, 0, v159, vcc
    s_mov_b64 exec, 0x3ff
    global_load_dword v159, v[158:159], off
    s_mov_b64 exec, -1
    s_waitcnt lgkmcnt(0)
    s_mov_b32 s24, s4
    s_mov_b32 s25, s5
    buffer_load_dwordx4 v[160:163], v13, s[24:27], s74 offen offset:0
    buffer_load_dwordx4 v[164:167], v13, s[24:27], s74 offen offset:256
    buffer_load_dwordx4 v[168:171], v13, s[24:27], s74 offen offset:512
    buffer_load_dwordx4 v[172:175], v13, s[24:27], s74 offen offset:768
    buffer_load_dwordx4 v[176:179], v13, s[24:27], s74 offen offset:128
    buffer_load_dwordx4 v[180:183], v13, s[24:27], s74 offen offset:384
    buffer_load_dwordx4 v[184:187], v13, s[24:27], s74 offen offset:640
    buffer_load_dwordx4 v[188:191], v13, s[24:27], s74 offen offset:896
    s_add_u32 s0, s36, 15593472
    s_addc_u32 s1, s37, 0
    s_load_dword s22, s[0:1], 0
    v_add_f32 v22, 0x3b000000, v252
    v_fma_f32 v23, v22, v254, v253
    v_mul_f32 v248, 2.0, v22
    v_mul_f32 v250, 0x42000000, v22
    v_mov_b32 v232, v23
    v_fmamk_f32 v233, v22, 0x3f800000, v23
    v_fmamk_f32 v234, v22, 0x40000000, v23
    v_fmamk_f32 v235, v22, 0x40400000, v23
    v_fmamk_f32 v240, v22, 0x42000000, v23
    v_fmamk_f32 v241, v22, 0x42040000, v23
    v_fmamk_f32 v242, v22, 0x42080000, v23
    v_fmamk_f32 v243, v22, 0x420c0000, v23
    v_cos_f32 v248, v248
    v_cos_f32 v250, v250
    v_cos_f32 v232, v232
    v_cos_f32 v233, v233
    v_cos_f32 v234, v234
    v_cos_f32 v235, v235
    v_cos_f32 v240, v240
    v_cos_f32 v241, v241
    v_cos_f32 v242, v242
    v_cos_f32 v243, v243
    v_add_f32 v249, v248, v248
    v_add_f32 v251, v250, v250
    v_add_f32 v248, v248, v248
    v_add_f32 v250, v250, v250
    v_pk_fma_f32 v[236:237], v[248:249], v[234:235], v[232:233] neg_lo:[0,0,1] neg_hi:[0,0,1]
    v_pk_fma_f32 v[244:245], v[248:249], v[242:243], v[240:241] neg_lo:[0,0,1] neg_hi:[0,0,1]
    v_pk_fma_f32 v[238:239], v[248:249], v[236:237], v[234:235] neg_lo:[0,0,1] neg_hi:[0,0,1]
    v_pk_fma_f32 v[246:247], v[248:249], v[244:245], v[242:243] neg_lo:[0,0,1] neg_hi:[0,0,1]
    v_cvt_pk_bf16_f32 v40, v232, v233
    v_cvt_pk_bf16_f32 v41, v234, v235
    v_cvt_pk_bf16_f32 v42, v236, v237
    v_cvt_pk_bf16_f32 v43, v238, v239
    v_pk_fma_f32 v[232:233], v[250:251], v[240:241], v[232:233] neg_lo:[0,0,1] neg_hi:[0,0,1]
    v_pk_fma_f32 v[234:235], v[250:251], v[242:243], v[234:235] neg_lo:[0,0,1] neg_hi:[0,0,1]
    v_pk_fma_f32 v[236:237], v[250:251], v[244:245], v[236:237] neg_lo:[0,0,1] neg_hi:[0,0,1]
    v_pk_fma_f32 v[238:239], v[250:251], v[246:247], v[238:239] neg_lo:[0,0,1] neg_hi:[0,0,1]
    v_cvt_pk_bf16_f32 v44, v240, v241
    v_cvt_pk_bf16_f32 v45, v242, v243
    v_cvt_pk_bf16_f32 v46, v244, v245
    v_cvt_pk_bf16_f32 v47, v246, v247
    v_pk_fma_f32 v[240:241], v[250:251], v[232:233], v[240:241] neg_lo:[0,0,1] neg_hi:[0,0,1]
    v_pk_fma_f32 v[242:243], v[250:251], v[234:235], v[242:243] neg_lo:[0,0,1] neg_hi:[0,0,1]
    v_pk_fma_f32 v[244:245], v[250:251], v[236:237], v[244:245] neg_lo:[0,0,1] neg_hi:[0,0,1]
    v_pk_fma_f32 v[246:247], v[250:251], v[238:239], v[246:247] neg_lo:[0,0,1] neg_hi:[0,0,1]
    v_cvt_pk_bf16_f32 v48, v232, v233
    v_cvt_pk_bf16_f32 v49, v234, v235
    v_cvt_pk_bf16_f32 v50, v236, v237
    v_cvt_pk_bf16_f32 v51, v238, v239
    v_cvt_pk_bf16_f32 v52, v240, v241
    v_cvt_pk_bf16_f32 v53, v242, v243
    v_cvt_pk_bf16_f32 v54, v244, v245
    v_cvt_pk_bf16_f32 v55, v246, v247
    v_add_f32 v22, 0x3bc00000, v252
    v_fma_f32 v23, v22, v254, v253
    v_mul_f32 v248, 2.0, v22
    v_mul_f32 v250, 0x42000000, v22
    v_mov_b32 v232, v23
    v_fmamk_f32 v233, v22, 0x3f800000, v23
    v_fmamk_f32 v234, v22, 0x40000000, v23
    v_fmamk_f32 v235, v22, 0x40400000, v23
    v_fmamk_f32 v240, v22, 0x42000000, v23
    v_fmamk_f32 v241, v22, 0x42040000, v23
    v_fmamk_f32 v242, v22, 0x42080000, v23
    v_fmamk_f32 v243, v22, 0x420c0000, v23
    v_cos_f32 v248, v248
    v_cos_f32 v250, v250
    v_cos_f32 v232, v232
    v_cos_f32 v233, v233
    v_cos_f32 v234, v234
    v_cos_f32 v235, v235
    v_cos_f32 v240, v240
    v_cos_f32 v241, v241
    v_cos_f32 v242, v242
    v_cos_f32 v243, v243
    v_add_f32 v249, v248, v248
    v_add_f32 v251, v250, v250
    v_add_f32 v248, v248, v248
    v_add_f32 v250, v250, v250
    v_pk_fma_f32 v[236:237], v[248:249], v[234:235], v[232:233] neg_lo:[0,0,1] neg_hi:[0,0,1]
    v_pk_fma_f32 v[244:245], v[248:249], v[242:243], v[240:241] neg_lo:[0,0,1] neg_hi:[0,0,1]
    v_pk_fma_f32 v[238:239], v[248:249], v[236:237], v[234:235] neg_lo:[0,0,1] neg_hi:[0,0,1]
    v_pk_fma_f32 v[246:247], v[248:249], v[244:245], v[242:243] neg_lo:[0,0,1] neg_hi:[0,0,1]
    v_cvt_pk_bf16_f32 v72, v232, v233
    v_cvt_pk_bf16_f32 v73, v234, v235
    v_cvt_pk_bf16_f32 v74, v236, v237
    v_cvt_pk_bf16_f32 v75, v238, v239
    v_pk_fma_f32 v[232:233], v[250:251], v[240:241], v[232:233] neg_lo:[0,0,1] neg_hi:[0,0,1]
    v_pk_fma_f32 v[234:235], v[250:251], v[242:243], v[234:235] neg_lo:[0,0,1] neg_hi:[0,0,1]
    v_pk_fma_f32 v[236:237], v[250:251], v[244:245], v[236:237] neg_lo:[0,0,1] neg_hi:[0,0,1]
    v_pk_fma_f32 v[238:239], v[250:251], v[246:247], v[238:239] neg_lo:[0,0,1] neg_hi:[0,0,1]
    v_cvt_pk_bf16_f32 v76, v240, v241
    v_cvt_pk_bf16_f32 v77, v242, v243
    v_cvt_pk_bf16_f32 v78, v244, v245
    v_cvt_pk_bf16_f32 v79, v246, v247
    v_pk_fma_f32 v[240:241], v[250:251], v[232:233], v[240:241] neg_lo:[0,0,1] neg_hi:[0,0,1]
    v_pk_fma_f32 v[242:243], v[250:251], v[234:235], v[242:243] neg_lo:[0,0,1] neg_hi:[0,0,1]
    v_pk_fma_f32 v[244:245], v[250:251], v[236:237], v[244:245] neg_lo:[0,0,1] neg_hi:[0,0,1]
    v_pk_fma_f32 v[246:247], v[250:251], v[238:239], v[246:247] neg_lo:[0,0,1] neg_hi:[0,0,1]
    v_cvt_pk_bf16_f32 v80, v232, v233
    v_cvt_pk_bf16_f32 v81, v234, v235
    v_cvt_pk_bf16_f32 v82, v236, v237
    v_cvt_pk_bf16_f32 v83, v238, v239
    v_cvt_pk_bf16_f32 v84, v240, v241
    v_cvt_pk_bf16_f32 v85, v242, v243
    v_cvt_pk_bf16_f32 v86, v244, v245
    v_cvt_pk_bf16_f32 v87, v246, v247
    s_mov_b32 s38, 16777216
    s_mov_b32 s39, 0x20000
    v_lshlrev_b32 v2, 4, v1
    s_mov_b32 s40, s6
    s_mov_b32 s41, s7
    s_mov_b32 s42, 1052672
    s_mov_b32 s43, 0x20000
    s_mov_b32 s44, s8
    s_mov_b32 s45, s9
    s_mov_b32 s46, 1052672
    s_mov_b32 s47, 0x20000
    s_lshr_b32 s10, s2, 6
    s_lshl_b32 s10, s10, 4
    s_add_u32 s10, s10, s58
    s_and_b32 s11, s2, 4
    s_lshl_b32 s11, s11, 1
    s_add_u32 s10, s10, s11
    s_and_b32 s11, s2, 0x38
    s_lshl_b32 s11, s11, 5
    s_add_u32 s10, s10, s11
    s_mul_i32 s10, s10, 514
    s_andn2_b32 s10, s10, 3
    s_and_b32 s63, s2, 3
    s_lshl_b32 s11, s63, 7
    s_add_u32 s6, s10, s11
    s_mul_i32 s62, s58, 1168
    s_add_u32 s62, s62, 147456
    v_mul_u32_u24 v18, 57, v1
    v_lshrrev_b32 v18, 9, v18
    v_mul_u32_u24 v18, 32752, v18
    v_add_u32 v208, v18, v2
    v_and_b32 v18, 7, v1
    v_mul_u32_u24 v19, 1168, v18
    v_and_b32 v20, 1, v1
    v_add_u32 v20, v20, v17
    v_lshl_add_u32 v19, v20, 1, v19
    s_lshl_b32 s10, s58, 4
    s_add_u32 s10, s10, 147456
    v_add_u32 v209, s10, v19
    v_lshlrev_b32 v18, 4, v18
    v_lshl_add_u32 v210, v17, 13, v18
    s_lshr_b32 s4, s2, 2
    s_lshl_b32 s4, s4, 7
    s_lshl_b32 s10, s2, 7
    s_add_u32 s76, s10, 15597568
    s_lshl_b32 s10, s63, 19
    s_lshl_b32 s11, s58, 16
    s_add_u32 s10, s10, s11
    s_add_u32 s7, s10, s4
    s_add_u32 s7, s7, 11534336
    s_add_u32 s5, s4, 13631488
    s_add_u32 m0, s62, 0
    s_mov_b32 exec_hi, 15
    buffer_load_dwordx4 v208, s[40:43], s6 offen lds
    s_mov_b32 exec_hi, -1
    s_add_u32 m0, s62, 576
    s_mov_b32 exec_hi, 15
    buffer_load_dwordx4 v208, s[44:47], s6 offen lds
    s_mov_b32 exec_hi, -1
    v_and_b32 v232, 15, v1
    s_lshl_b32 s10, s58, 4
    v_add_u32 v232, s10, v232
    v_cmp_eq_u32 vcc, 1, v232
    s_nop 1
    v_cndmask_b32 v22, v252, 0.5, vcc
    v_cndmask_b32 v233, v253, 0, vcc
    v_fma_f32 v23, v22, v254, v233
    v_mul_f32 v248, 2.0, v22
    v_mul_f32 v250, 0x42000000, v22
    v_mov_b32 v232, v23
    v_fmamk_f32 v233, v22, 0x3f800000, v23
    v_fmamk_f32 v234, v22, 0x40000000, v23
    v_fmamk_f32 v235, v22, 0x40400000, v23
    v_fmamk_f32 v240, v22, 0x42000000, v23
    v_fmamk_f32 v241, v22, 0x42040000, v23
    v_fmamk_f32 v242, v22, 0x42080000, v23
    v_fmamk_f32 v243, v22, 0x420c0000, v23
    v_cos_f32 v248, v248
    v_cos_f32 v250, v250
    v_cos_f32 v232, v232
    v_cos_f32 v233, v233
    v_cos_f32 v234, v234
    v_cos_f32 v235, v235
    v_cos_f32 v240, v240
    v_cos_f32 v241, v241
    v_cos_f32 v242, v242
    v_cos_f32 v243, v243
    v_add_f32 v249, v248, v248
    v_add_f32 v251, v250, v250
    v_add_f32 v248, v248, v248
    v_add_f32 v250, v250, v250
    v_pk_fma_f32 v[236:237], v[248:249], v[234:235], v[232:233] neg_lo:[0,0,1] neg_hi:[0,0,1]
    v_pk_fma_f32 v[244:245], v[248:249], v[242:243], v[240:241] neg_lo:[0,0,1] neg_hi:[0,0,1]
    v_pk_fma_f32 v[238:239], v[248:249], v[236:237], v[234:235] neg_lo:[0,0,1] neg_hi:[0,0,1]
    v_pk_fma_f32 v[246:247], v[248:249], v[244:245], v[242:243] neg_lo:[0,0,1] neg_hi:[0,0,1]
    v_cvt_pk_bf16_f32 v24, v232, v233
    v_cvt_pk_bf16_f32 v25, v234, v235
    v_cvt_pk_bf16_f32 v26, v236, v237
    v_cvt_pk_bf16_f32 v27, v238, v239
    v_pk_fma_f32 v[232:233], v[250:251], v[240:241], v[232:233] neg_lo:[0,0,1] neg_hi:[0,0,1]
    v_pk_fma_f32 v[234:235], v[250:251], v[242:243], v[234:235] neg_lo:[0,0,1] neg_hi:[0,0,1]
    v_pk_fma_f32 v[236:237], v[250:251], v[244:245], v[236:237] neg_lo:[0,0,1] neg_hi:[0,0,1]
    v_pk_fma_f32 v[238:239], v[250:251], v[246:247], v[238:239] neg_lo:[0,0,1] neg_hi:[0,0,1]
    v_cvt_pk_bf16_f32 v28, v240, v241
    v_cvt_pk_bf16_f32 v29, v242, v243
    v_cvt_pk_bf16_f32 v30, v244, v245
    v_cvt_pk_bf16_f32 v31, v246, v247
    v_pk_fma_f32 v[240:241], v[250:251], v[232:233], v[240:241] neg_lo:[0,0,1] neg_hi:[0,0,1]
    v_pk_fma_f32 v[242:243], v[250:251], v[234:235], v[242:243] neg_lo:[0,0,1] neg_hi:[0,0,1]
    v_pk_fma_f32 v[244:245], v[250:251], v[236:237], v[244:245] neg_lo:[0,0,1] neg_hi:[0,0,1]
    v_pk_fma_f32 v[246:247], v[250:251], v[238:239], v[246:247] neg_lo:[0,0,1] neg_hi:[0,0,1]
    v_cvt_pk_bf16_f32 v32, v232, v233
    v_cvt_pk_bf16_f32 v33, v234, v235
    v_cvt_pk_bf16_f32 v34, v236, v237
    v_cvt_pk_bf16_f32 v35, v238, v239
    v_cvt_pk_bf16_f32 v36, v240, v241
    v_cvt_pk_bf16_f32 v37, v242, v243
    v_cvt_pk_bf16_f32 v38, v244, v245
    v_cvt_pk_bf16_f32 v39, v246, v247
    s_and_b32 s80, s58, 3
    v_and_b32 v21, 15, v1
    s_lshl_b32 s11, s73, 8
    v_bfe_u32 v18, v1, 1, 3
    v_xor_b32 v18, v16, v18
    v_lshlrev_b32 v18, 4, v18
    v_lshl_add_u32 v152, v21, 7, v18
    v_add_u32 v152, 81920, v152
    v_xor_b32 v153, 64, v152
    v_and_b32 v154, 0x70, v13
    v_mul_u32_u24 v155, 65536, v16
    v_lshl_add_u32 v155, v21, 4, v155
    s_mul_i32 s10, s58, 262144
    s_add_u32 s10, s10, s11
    s_add_u32 s64, s10, 7340032
    s_add_u32 s10, s75, 81920
    v_add_u32 v156, s10, v2
    s_lshl_b32 s10, s73, 7
    s_add_u32 s77, s10, 15663104
    s_waitcnt lgkmcnt(0)
    s_add_u32 s22, s22, 1
    s_xor_b32 s23, s22, 0x9e3779b9
    v_add_f32 v22, 0x3b800000, v252
    v_fma_f32 v23, v22, v254, v253
    v_mul_f32 v248, 2.0, v22
    v_mul_f32 v250, 0x42000000, v22
    v_mov_b32 v232, v23
    v_fmamk_f32 v233, v22, 0x3f800000, v23
    v_fmamk_f32 v234, v22, 0x40000000, v23
    v_fmamk_f32 v235, v22, 0x40400000, v23
    v_fmamk_f32 v240, v22, 0x42000000, v23
    v_fmamk_f32 v241, v22, 0x42040000, v23
    v_fmamk_f32 v242, v22, 0x42080000, v23
    v_fmamk_f32 v243, v22, 0x420c0000, v23
    v_cos_f32 v248, v248
    v_cos_f32 v250, v250
    v_cos_f32 v232, v232
    v_cos_f32 v233, v233
    v_cos_f32 v234, v234
    v_cos_f32 v235, v235
    v_cos_f32 v240, v240
    v_cos_f32 v241, v241
    v_cos_f32 v242, v242
    v_cos_f32 v243, v243
    v_add_f32 v249, v248, v248
    v_add_f32 v251, v250, v250
    v_add_f32 v248, v248, v248
    v_add_f32 v250, v250, v250
    v_pk_fma_f32 v[236:237], v[248:249], v[234:235], v[232:233] neg_lo:[0,0,1] neg_hi:[0,0,1]
    v_pk_fma_f32 v[244:245], v[248:249], v[242:243], v[240:241] neg_lo:[0,0,1] neg_hi:[0,0,1]
    v_pk_fma_f32 v[238:239], v[248:249], v[236:237], v[234:235] neg_lo:[0,0,1] neg_hi:[0,0,1]
    v_pk_fma_f32 v[246:247], v[248:249], v[244:245], v[242:243] neg_lo:[0,0,1] neg_hi:[0,0,1]
    v_cvt_pk_bf16_f32 v56, v232, v233
    v_cvt_pk_bf16_f32 v57, v234, v235
    v_cvt_pk_bf16_f32 v58, v236, v237
    v_cvt_pk_bf16_f32 v59, v238, v239
    v_pk_fma_f32 v[232:233], v[250:251], v[240:241], v[232:233] neg_lo:[0,0,1] neg_hi:[0,0,1]
    v_pk_fma_f32 v[234:235], v[250:251], v[242:243], v[234:235] neg_lo:[0,0,1] neg_hi:[0,0,1]
    v_pk_fma_f32 v[236:237], v[250:251], v[244:245], v[236:237] neg_lo:[0,0,1] neg_hi:[0,0,1]
    v_pk_fma_f32 v[238:239], v[250:251], v[246:247], v[238:239] neg_lo:[0,0,1] neg_hi:[0,0,1]
    v_cvt_pk_bf16_f32 v60, v240, v241
    v_cvt_pk_bf16_f32 v61, v242, v243
    v_cvt_pk_bf16_f32 v62, v244, v245
    v_cvt_pk_bf16_f32 v63, v246, v247
    v_pk_fma_f32 v[240:241], v[250:251], v[232:233], v[240:241] neg_lo:[0,0,1] neg_hi:[0,0,1]
    v_pk_fma_f32 v[242:243], v[250:251], v[234:235], v[242:243] neg_lo:[0,0,1] neg_hi:[0,0,1]
    v_pk_fma_f32 v[244:245], v[250:251], v[236:237], v[244:245] neg_lo:[0,0,1] neg_hi:[0,0,1]
    v_pk_fma_f32 v[246:247], v[250:251], v[238:239], v[246:247] neg_lo:[0,0,1] neg_hi:[0,0,1]
    v_cvt_pk_bf16_f32 v64, v232, v233
    v_cvt_pk_bf16_f32 v65, v234, v235
    v_cvt_pk_bf16_f32 v66, v236, v237
    v_cvt_pk_bf16_f32 v67, v238, v239
    v_cvt_pk_bf16_f32 v68, v240, v241
    v_cvt_pk_bf16_f32 v69, v242, v243
    v_cvt_pk_bf16_f32 v70, v244, v245
    v_cvt_pk_bf16_f32 v71, v246, v247
    s_mov_b32 s52, s18
    s_mov_b32 s53, s19
    s_mov_b32 s54, 1024
    s_mov_b32 s55, 0x20000
    buffer_load_dwordx4 v[224:227], v154, s[52:55], 0 offen offset:0
    buffer_load_dwordx4 v[228:231], v154, s[52:55], 0 offen offset:256
    buffer_load_dwordx4 v[232:235], v154, s[52:55], 0 offen offset:512
    buffer_load_dwordx4 v[236:239], v154, s[52:55], 0 offen offset:768
    buffer_load_dwordx4 v[240:243], v154, s[52:55], 0 offen offset:128
    buffer_load_dwordx4 v[244:247], v154, s[52:55], 0 offen offset:384
    buffer_load_dwordx4 v[248:251], v154, s[52:55], 0 offen offset:640
    buffer_load_dwordx4 v[252:255], v154, s[52:55], 0 offen offset:896
    s_waitcnt vmcnt(14)
    v_lshlrev_b32 v88, 16, v160
    v_and_b32 v89, 0xffff0000, v160
    v_lshlrev_b32 v90, 16, v161
    v_and_b32 v91, 0xffff0000, v161
    v_lshlrev_b32 v92, 16, v162
    v_and_b32 v93, 0xffff0000, v162
    v_lshlrev_b32 v94, 16, v163
    v_and_b32 v95, 0xffff0000, v163
    v_lshlrev_b32 v96, 16, v164
    v_and_b32 v97, 0xffff0000, v164
    v_lshlrev_b32 v98, 16, v165
    v_and_b32 v99, 0xffff0000, v165
    v_lshlrev_b32 v100, 16, v166
    v_and_b32 v101, 0xffff0000, v166
    v_lshlrev_b32 v102, 16, v167
    v_and_b32 v103, 0xffff0000, v167
    v_lshlrev_b32 v104, 16, v168
    v_and_b32 v105, 0xffff0000, v168
    v_lshlrev_b32 v106, 16, v169
    v_and_b32 v107, 0xffff0000, v169
    v_lshlrev_b32 v108, 16, v170
    v_and_b32 v109, 0xffff0000, v170
    v_lshlrev_b32 v110, 16, v171
    v_and_b32 v111, 0xffff0000, v171
    v_lshlrev_b32 v112, 16, v172
    v_and_b32 v113, 0xffff0000, v172
    v_lshlrev_b32 v114, 16, v173
    v_and_b32 v115, 0xffff0000, v173
    v_lshlrev_b32 v116, 16, v174
    v_and_b32 v117, 0xffff0000, v174
    v_lshlrev_b32 v118, 16, v175
    v_and_b32 v119, 0xffff0000, v175
    v_pk_add_f32 v[120:121], v[88:89], v[104:105]
    v_pk_add_f32 v[128:129], v[96:97], v[112:113]
    v_pk_add_f32 v[104:105], v[88:89], v[104:105] neg_lo:[0,1] neg_hi:[0,1]
    v_pk_add_f32 v[112:113], v[96:97], v[112:113] neg_lo:[0,1] neg_hi:[0,1]
    v_pk_add_f32 v[122:123], v[90:91], v[106:107]
    v_pk_add_f32 v[130:131], v[98:99], v[114:115]
    v_pk_add_f32 v[106:107], v[90:91], v[106:107] neg_lo:[0,1] neg_hi:[0,1]
    v_pk_add_f32 v[114:115], v[98:99], v[114:115] neg_lo:[0,1] neg_hi:[0,1]
    v_pk_add_f32 v[124:125], v[92:93], v[108:109]
    v_pk_add_f32 v[132:133], v[100:101], v[116:117]
    v_pk_add_f32 v[108:109], v[92:93], v[108:109] neg_lo:[0,1] neg_hi:[0,1]
    v_pk_add_f32 v[116:117], v[100:101], v[116:117] neg_lo:[0,1] neg_hi:[0,1]
    v_pk_add_f32 v[126:127], v[94:95], v[110:111]
    v_pk_add_f32 v[134:135], v[102:103], v[118:119]
    v_pk_add_f32 v[110:111], v[94:95], v[110:111] neg_lo:[0,1] neg_hi:[0,1]
    v_pk_add_f32 v[118:119], v[102:103], v[118:119] neg_lo:[0,1] neg_hi:[0,1]
    v_pk_add_f32 v[88:89], v[120:121], v[128:129]
    v_pk_add_f32 v[96:97], v[120:121], v[128:129] neg_lo:[0,1] neg_hi:[0,1]
    v_pk_add_f32 v[90:91], v[122:123], v[130:131]
    v_pk_add_f32 v[98:99], v[122:123], v[130:131] neg_lo:[0,1] neg_hi:[0,1]
    v_pk_add_f32 v[92:93], v[124:125], v[132:133]
    v_pk_add_f32 v[100:101], v[124:125], v[132:133] neg_lo:[0,1] neg_hi:[0,1]
    v_pk_add_f32 v[94:95], v[126:127], v[134:135]
    v_pk_add_f32 v[102:103], v[126:127], v[134:135] neg_lo:[0,1] neg_hi:[0,1]
    v_cvt_pk_bf16_f32 v144, v104, v105
    v_cvt_pk_bf16_f32 v145, v106, v107
    v_cvt_pk_bf16_f32 v146, v108, v109
    v_cvt_pk_bf16_f32 v147, v110, v111
    ds_write_b128 v156, v[144:147] offset:32768
    v_cvt_pk_bf16_f32 v148, v112, v113
    v_cvt_pk_bf16_f32 v149, v114, v115
    v_cvt_pk_bf16_f32 v150, v116, v117
    v_cvt_pk_bf16_f32 v151, v118, v119
    ds_write_b128 v156, v[148:151] offset:49152
    v_cvt_pk_bf16_f32 v136, v88, v89
    v_cvt_pk_bf16_f32 v137, v90, v91
    v_cvt_pk_bf16_f32 v138, v92, v93
    v_cvt_pk_bf16_f32 v139, v94, v95
    ds_write_b128 v156, v[136:139] offset:0
    v_cvt_pk_bf16_f32 v140, v96, v97
    v_cvt_pk_bf16_f32 v141, v98, v99
    v_cvt_pk_bf16_f32 v142, v100, v101
    v_cvt_pk_bf16_f32 v143, v102, v103
    ds_write_b128 v156, v[140:143] offset:16384
    s_waitcnt vmcnt(10)
    v_lshlrev_b32 v88, 16, v176
    v_and_b32 v89, 0xffff0000, v176
    v_lshlrev_b32 v90, 16, v177
    v_and_b32 v91, 0xffff0000, v177
    v_lshlrev_b32 v92, 16, v178
    v_and_b32 v93, 0xffff0000, v178
    v_lshlrev_b32 v94, 16, v179
    v_and_b32 v95, 0xffff0000, v179
    v_lshlrev_b32 v96, 16, v180
    v_and_b32 v97, 0xffff0000, v180
    v_lshlrev_b32 v98, 16, v181
    v_and_b32 v99, 0xffff0000, v181
    v_lshlrev_b32 v100, 16, v182
    v_and_b32 v101, 0xffff0000, v182
    v_lshlrev_b32 v102, 16, v183
    v_and_b32 v103, 0xffff0000, v183
    v_lshlrev_b32 v104, 16, v184
    v_and_b32 v105, 0xffff0000, v184
    v_lshlrev_b32 v106, 16, v185
    v_and_b32 v107, 0xffff0000, v185
    v_lshlrev_b32 v108, 16, v186
    v_and_b32 v109, 0xffff0000, v186
    v_lshlrev_b32 v110, 16, v187
    v_and_b32 v111, 0xffff0000, v187
    v_lshlrev_b32 v112, 16, v188
    v_and_b32 v113, 0xffff0000, v188
    v_lshlrev_b32 v114, 16, v189
    v_and_b32 v115, 0xffff0000, v189
    v_lshlrev_b32 v116, 16, v190
    v_and_b32 v117, 0xffff0000, v190
    v_lshlrev_b32 v118, 16, v191
    v_and_b32 v119, 0xffff0000, v191
    v_pk_add_f32 v[120:121], v[88:89], v[104:105]
    v_pk_add_f32 v[128:129], v[96:97], v[112:113]
    v_pk_add_f32 v[104:105], v[88:89], v[104:105] neg_lo:[0,1] neg_hi:[0,1]
    v_pk_add_f32 v[112:113], v[96:97], v[112:113] neg_lo:[0,1] neg_hi:[0,1]
    v_pk_add_f32 v[122:123], v[90:91], v[106:107]
    v_pk_add_f32 v[130:131], v[98:99], v[114:115]
    v_pk_add_f32 v[106:107], v[90:91], v[106:107] neg_lo:[0,1] neg_hi:[0,1]
    v_pk_add_f32 v[114:115], v[98:99], v[114:115] neg_lo:[0,1] neg_hi:[0,1]
    v_pk_add_f32 v[124:125], v[92:93], v[108:109]
    v_pk_add_f32 v[132:133], v[100:101], v[116:117]
    v_pk_add_f32 v[108:109], v[92:93], v[108:109] neg_lo:[0,1] neg_hi:[0,1]
    v_pk_add_f32 v[116:117], v[100:101], v[116:117] neg_lo:[0,1] neg_hi:[0,1]
    v_pk_add_f32 v[126:127], v[94:95], v[110:111]
    v_pk_add_f32 v[134:135], v[102:103], v[118:119]
    v_pk_add_f32 v[110:111], v[94:95], v[110:111] neg_lo:[0,1] neg_hi:[0,1]
    v_pk_add_f32 v[118:119], v[102:103], v[118:119] neg_lo:[0,1] neg_hi:[0,1]
    v_pk_add_f32 v[88:89], v[120:121], v[128:129]
    v_pk_add_f32 v[96:97], v[120:121], v[128:129] neg_lo:[0,1] neg_hi:[0,1]
    v_pk_add_f32 v[90:91], v[122:123], v[130:131]
    v_pk_add_f32 v[98:99], v[122:123], v[130:131] neg_lo:[0,1] neg_hi:[0,1]
    v_pk_add_f32 v[92:93], v[124:125], v[132:133]
    v_pk_add_f32 v[100:101], v[124:125], v[132:133] neg_lo:[0,1] neg_hi:[0,1]
    v_pk_add_f32 v[94:95], v[126:127], v[134:135]
    v_pk_add_f32 v[102:103], v[126:127], v[134:135] neg_lo:[0,1] neg_hi:[0,1]
    v_cvt_pk_bf16_f32 v144, v104, v105
    v_cvt_pk_bf16_f32 v145, v106, v107
    v_cvt_pk_bf16_f32 v146, v108, v109
    v_cvt_pk_bf16_f32 v147, v110, v111
    ds_write_b128 v156, v[144:147] offset:40960
    v_cvt_pk_bf16_f32 v148, v112, v113
    v_cvt_pk_bf16_f32 v149, v114, v115
    v_cvt_pk_bf16_f32 v150, v116, v117
    v_cvt_pk_bf16_f32 v151, v118, v119
    ds_write_b128 v156, v[148:151] offset:57344
    v_cvt_pk_bf16_f32 v136, v88, v89
    v_cvt_pk_bf16_f32 v137, v90, v91
    v_cvt_pk_bf16_f32 v138, v92, v93
    v_cvt_pk_bf16_f32 v139, v94, v95
    ds_write_b128 v156, v[136:139] offset:8192
    v_cvt_pk_bf16_f32 v140, v96, v97
    v_cvt_pk_bf16_f32 v141, v98, v99
    v_cvt_pk_bf16_f32 v142, v100, v101
    v_cvt_pk_bf16_f32 v143, v102, v103
    ds_write_b128 v156, v[140:143] offset:24576
    s_waitcnt lgkmcnt(0)
    s_waitcnt vmcnt(8)
    s_barrier
    ds_read_u16 v192, v209 offset:0
    ds_read_u16 v196, v209 offset:576
    ds_read_u16 v193, v209 offset:144
    ds_read_u16 v197, v209 offset:720
    ds_read_u16 v194, v209 offset:288
    ds_read_u16 v198, v209 offset:864
    ds_read_u16 v195, v209 offset:432
    ds_read_u16 v199, v209 offset:1008
    s_lshl_b32 s10, s58, 2
    s_add_u32 s10, s10, s63
    s_cmp_lg_u32 s10, 3
    s_cbranch_scc1 PK_NOA2SX
    v_lshrrev_b32 v200, 2, v1
    v_and_b32 v201, 1, v200
    v_mul_u32_u24 v200, 1168, v200
    v_lshl_add_u32 v200, v201, 1, v200
    v_and_b32 v201, 3, v1
    v_mul_u32_u24 v201, 144, v201
    v_add_u32 v200, v200, v201
    v_add_u32 v200, 147584, v200
    v_lshlrev_b32 v202, 2, v1
    s_mov_b32 exec_hi, 0
    ds_read_u16 v201, v200 offset:576
    ds_read_u16 v200, v200
    s_waitcnt lgkmcnt(0)
    v_lshl_or_b32 v200, v201, 16, v200
    buffer_store_dword v200, v202, s[36:39], s5 offen sc1
    s_mov_b32 exec_hi, -1
PK_NOA2SX:
    s_waitcnt lgkmcnt(0)
    v_lshl_or_b32 v192, v196, 16, v192
    v_lshl_or_b32 v193, v197, 16, v193
    v_lshl_or_b32 v194, v198, 16, v194
    v_lshl_or_b32 v195, v199, 16, v195
    buffer_store_dwordx4 v[192:195], v210, s[36:39], s7 offen sc1
    ds_read_b128 v[88:91], v152 offset:32768
    ds_read_b128 v[92:95], v152 offset:34816
    ds_read_b128 v[96:99], v152 offset:36864
    ds_read_b128 v[100:103], v152 offset:38912
    ds_read_b128 v[104:107], v153 offset:32768
    ds_read_b128 v[108:111], v153 offset:34816
    ds_read_b128 v[112:115], v153 offset:36864
    ds_read_b128 v[116:119], v153 offset:38912
    ds_read_b128 v[120:123], v152 offset:40960
    s_waitcnt vmcnt(1)
    v_mov_b32 v157, 0
    v_dot2c_f32_bf16 v157, v160, v224
    v_dot2c_f32_bf16 v157, v161, v225
    v_dot2c_f32_bf16 v157, v162, v226
    v_dot2c_f32_bf16 v157, v163, v227
    v_dot2c_f32_bf16 v157, v164, v228
    v_dot2c_f32_bf16 v157, v165, v229
    v_dot2c_f32_bf16 v157, v166, v230
    v_dot2c_f32_bf16 v157, v167, v231
    v_dot2c_f32_bf16 v157, v168, v232
    v_dot2c_f32_bf16 v157, v169, v233
    v_dot2c_f32_bf16 v157, v170, v234
    v_dot2c_f32_bf16 v157, v171, v235
    v_dot2c_f32_bf16 v157, v172, v236
    v_dot2c_f32_bf16 v157, v173, v237
    v_dot2c_f32_bf16 v157, v174, v238
    v_dot2c_f32_bf16 v157, v175, v239
    v_dot2c_f32_bf16 v157, v176, v240
    v_dot2c_f32_bf16 v157, v177, v241
    v_dot2c_f32_bf16 v157, v178, v242
    v_dot2c_f32_bf16 v157, v179, v243
    v_dot2c_f32_bf16 v157, v180, v244
    v_dot2c_f32_bf16 v157, v181, v245
    v_dot2c_f32_bf16 v157, v182, v246
    v_dot2c_f32_bf16 v157, v183, v247
    v_dot2c_f32_bf16 v157, v184, v248
    v_dot2c_f32_bf16 v157, v185, v249
    v_dot2c_f32_bf16 v157, v186, v250
    v_dot2c_f32_bf16 v157, v187, v251
    v_dot2c_f32_bf16 v157, v188, v252
    v_dot2c_f32_bf16 v157, v189, v253
    v_dot2c_f32_bf16 v157, v190, v254
    v_dot2c_f32_bf16 v157, v191, v255
    s_nop 2
    v_add_f32_dpp v157, v157, v157 quad_perm:[1,0,3,2] row_mask:0xf bank_mask:0xf
    s_nop 1
    v_add_f32_dpp v157, v157, v157 quad_perm:[2,3,0,1] row_mask:0xf bank_mask:0xf
    s_nop 1
    v_add_f32_dpp v157, v157, v157 row_half_mirror row_mask:0xf bank_mask:0xf
    v_mul_f32 v157, 0xbfb8aa3b, v157
    v_exp_f32 v157, v157
    v_lshlrev_b32 v18, 4, v17
    v_add_f32 v157, 1.0, v157
    v_rcp_f32 v157, v157
    s_and_b32 s10, s58, 1
    s_lshl_b32 s10, s10, 7
    s_lshr_b32 s11, s58, 1
    s_lshl_b32 s11, s11, 2
    s_add_u32 s10, s10, s11
    s_lshl_b32 s11, s73, 8
    s_add_u32 s10, s10, s11
    s_add_u32 s10, s10, 15532032
    s_mov_b32 exec_lo, 0x01010101
    s_mov_b32 exec_hi, 0x01010101
    buffer_store_dword v157, v18, s[36:39], s10 offen sc1
    s_mov_b64 exec, -1
    s_mul_i32 s10, s73, 7
    s_add_u32 s10, s10, s58
    s_lshl_b32 s10, s10, 13
    s_mov_b32 s48, s16
    s_mov_b32 s49, s17
    s_mov_b32 s50, 1835008
    s_mov_b32 s51, 0x20000
    v_lshlrev_b32 v12, 7, v1
    s_cmp_eq_u32 s58, 7
    s_cbranch_scc1 PK_FDD
    buffer_load_dword v159, v12, s[48:51], s10 offen
PK_FDD:
    s_waitcnt lgkmcnt(8)
    v_mfma_f32_16x16x32_bf16 v[192:195], v[40:43], v[88:91], 0
    v_mfma_f32_16x16x32_bf16 v[208:211], v[72:75], v[88:91], 0
    ds_read_b128 v[124:127], v152 offset:43008
    s_waitcnt lgkmcnt(8)
    v_mfma_f32_16x16x32_bf16 v[196:199], v[40:43], v[92:95], 0
    v_mfma_f32_16x16x32_bf16 v[212:215], v[72:75], v[92:95], 0
    ds_read_b128 v[128:131], v152 offset:45056
    s_waitcnt lgkmcnt(8)
    v_mfma_f32_16x16x32_bf16 v[200:203], v[40:43], v[96:99], 0
    v_mfma_f32_16x16x32_bf16 v[216:219], v[72:75], v[96:99], 0
    ds_read_b128 v[132:135], v152 offset:47104
    s_waitcnt lgkmcnt(8)
    v_mfma_f32_16x16x32_bf16 v[204:207], v[40:43], v[100:103], 0
    v_mfma_f32_16x16x32_bf16 v[220:223], v[72:75], v[100:103], 0
    ds_read_b128 v[88:91], v153 offset:40960
    s_waitcnt lgkmcnt(8)
    v_mfma_f32_16x16x32_bf16 v[192:195], v[44:47], v[104:107], v[192:195]
    v_mfma_f32_16x16x32_bf16 v[208:211], v[76:79], v[104:107], v[208:211]
    ds_read_b128 v[92:95], v153 offset:43008
    s_waitcnt lgkmcnt(8)
    v_mfma_f32_16x16x32_bf16 v[196:199], v[44:47], v[108:111], v[196:199]
    v_mfma_f32_16x16x32_bf16 v[212:215], v[76:79], v[108:111], v[212:215]
    ds_read_b128 v[96:99], v153 offset:45056
    s_waitcnt lgkmcnt(8)
    v_mfma_f32_16x16x32_bf16 v[200:203], v[44:47], v[112:115], v[200:203]
    v_mfma_f32_16x16x32_bf16 v[216:219], v[76:79], v[112:115], v[216:219]
    ds_read_b128 v[100:103], v153 offset:47104
    s_waitcnt lgkmcnt(8)
    v_mfma_f32_16x16x32_bf16 v[204:207], v[44:47], v[116:119], v[204:207]
    v_mfma_f32_16x16x32_bf16 v[220:223], v[76:79], v[116:119], v[220:223]
    ds_read_b128 v[104:107], v152 offset:49152
    s_waitcnt lgkmcnt(8)
    v_mfma_f32_16x16x32_bf16 v[192:195], v[48:51], v[120:123], v[192:195]
    v_mfma_f32_16x16x32_bf16 v[208:211], v[80:83], v[120:123], v[208:211]
    ds_read_b128 v[108:111], v152 offset:51200
    s_waitcnt lgkmcnt(8)
    v_mfma_f32_16x16x32_bf16 v[196:199], v[48:51], v[124:127], v[196:199]
    v_mfma_f32_16x16x32_bf16 v[212:215], v[80:83], v[124:127], v[212:215]
    ds_read_b128 v[112:115], v152 offset:53248
    s_waitcnt lgkmcnt(8)
    v_mfma_f32_16x16x32_bf16 v[200:203], v[48:51], v[128:131], v[200:203]
    v_mfma_f32_16x16x32_bf16 v[216:219], v[80:83], v[128:131], v[216:219]
    ds_read_b128 v[116:119], v152 offset:55296
    s_waitcnt lgkmcnt(8)
    v_mfma_f32_16x16x32_bf16 v[204:207], v[48:51], v[132:135], v[204:207]
    v_mfma_f32_16x16x32_bf16 v[220:223], v[80:83], v[132:135], v[220:223]
    ds_read_b128 v[120:123], v153 offset:49152
    s_waitcnt lgkmcnt(8)
    v_mfma_f32_16x16x32_bf16 v[192:195], v[52:55], v[88:91], v[192:195]
    v_mfma_f32_16x16x32_bf16 v[208:211], v[84:87], v[88:91], v[208:211]
    ds_read_b128 v[124:127], v153 offset:51200
    s_waitcnt lgkmcnt(8)
    v_mfma_f32_16x16x32_bf16 v[196:199], v[52:55], v[92:95], v[196:199]
    v_mfma_f32_16x16x32_bf16 v[212:215], v[84:87], v[92:95], v[212:215]
    ds_read_b128 v[128:131], v153 offset:53248
    s_waitcnt lgkmcnt(8)
    v_mfma_f32_16x16x32_bf16 v[200:203], v[52:55], v[96:99], v[200:203]
    v_mfma_f32_16x16x32_bf16 v[216:219], v[84:87], v[96:99], v[216:219]
    ds_read_b128 v[132:135], v153 offset:55296
    s_waitcnt lgkmcnt(8)
    v_mfma_f32_16x16x32_bf16 v[204:207], v[52:55], v[100:103], v[204:207]
    v_mfma_f32_16x16x32_bf16 v[220:223], v[84:87], v[100:103], v[220:223]
    ds_read_b128 v[88:91], v152 offset:57344
    s_waitcnt lgkmcnt(8)
    v_mfma_f32_16x16x32_bf16 v[232:235], v[40:43], v[104:107], 0
    v_mfma_f32_16x16x32_bf16 v[136:139], v[72:75], v[104:107], 0
    ds_read_b128 v[92:95], v152 offset:59392
    s_waitcnt lgkmcnt(8)
    v_mfma_f32_16x16x32_bf16 v[236:239], v[40:43], v[108:111], 0
    v_mfma_f32_16x16x32_bf16 v[140:143], v[72:75], v[108:111], 0
    ds_read_b128 v[96:99], v152 offset:61440
    s_waitcnt lgkmcnt(8)
    v_mfma_f32_16x16x32_bf16 v[240:243], v[40:43], v[112:115], 0
    v_mfma_f32_16x16x32_bf16 v[144:147], v[72:75], v[112:115], 0
    ds_read_b128 v[100:103], v152 offset:63488
    s_waitcnt lgkmcnt(8)
    v_mfma_f32_16x16x32_bf16 v[244:247], v[40:43], v[116:119], 0
    v_mfma_f32_16x16x32_bf16 v[148:151], v[72:75], v[116:119], 0
    ds_read_b128 v[104:107], v153 offset:57344
    s_waitcnt lgkmcnt(8)
    v_mfma_f32_16x16x32_bf16 v[232:235], v[44:47], v[120:123], v[232:235]
    v_mfma_f32_16x16x32_bf16 v[136:139], v[76:79], v[120:123], v[136:139]
    ds_read_b128 v[108:111], v153 offset:59392
    s_waitcnt lgkmcnt(8)
    v_mfma_f32_16x16x32_bf16 v[236:239], v[44:47], v[124:127], v[236:239]
    v_mfma_f32_16x16x32_bf16 v[140:143], v[76:79], v[124:127], v[140:143]
    ds_read_b128 v[112:115], v153 offset:61440
    s_waitcnt lgkmcnt(8)
    v_mfma_f32_16x16x32_bf16 v[240:243], v[44:47], v[128:131], v[240:243]
    v_mfma_f32_16x16x32_bf16 v[144:147], v[76:79], v[128:131], v[144:147]
    ds_read_b128 v[116:119], v153 offset:63488
    s_waitcnt lgkmcnt(8)
    v_mfma_f32_16x16x32_bf16 v[244:247], v[44:47], v[132:135], v[244:247]
    v_mfma_f32_16x16x32_bf16 v[148:151], v[76:79], v[132:135], v[148:151]
    ds_read_b128 v[120:123], v152 offset:0
    s_waitcnt lgkmcnt(8)
    v_mfma_f32_16x16x32_bf16 v[232:235], v[48:51], v[88:91], v[232:235]
    v_mfma_f32_16x16x32_bf16 v[136:139], v[80:83], v[88:91], v[136:139]
    ds_read_b128 v[124:127], v152 offset:2048
    s_waitcnt lgkmcnt(8)
    v_mfma_f32_16x16x32_bf16 v[236:239], v[48:51], v[92:95], v[236:239]
    v_mfma_f32_16x16x32_bf16 v[140:143], v[80:83], v[92:95], v[140:143]
    ds_read_b128 v[128:131], v152 offset:4096
    s_waitcnt lgkmcnt(8)
    v_mfma_f32_16x16x32_bf16 v[240:243], v[48:51], v[96:99], v[240:243]
    v_mfma_f32_16x16x32_bf16 v[144:147], v[80:83], v[96:99], v[144:147]
    ds_read_b128 v[132:135], v152 offset:6144
    s_waitcnt lgkmcnt(8)
    v_mfma_f32_16x16x32_bf16 v[244:247], v[48:51], v[100:103], v[244:247]
    v_mfma_f32_16x16x32_bf16 v[148:151], v[80:83], v[100:103], v[148:151]
    ds_read_b128 v[88:91], v153 offset:0
    s_waitcnt lgkmcnt(8)
    v_mfma_f32_16x16x32_bf16 v[232:235], v[52:55], v[104:107], v[232:235]
    v_mfma_f32_16x16x32_bf16 v[136:139], v[84:87], v[104:107], v[136:139]
    ds_read_b128 v[92:95], v153 offset:2048
    s_waitcnt lgkmcnt(8)
    v_mfma_f32_16x16x32_bf16 v[236:239], v[52:55], v[108:111], v[236:239]
    v_mfma_f32_16x16x32_bf16 v[140:143], v[84:87], v[108:111], v[140:143]
    ds_read_b128 v[96:99], v153 offset:4096
    s_waitcnt lgkmcnt(8)
    v_mfma_f32_16x16x32_bf16 v[240:243], v[52:55], v[112:115], v[240:243]
    v_mfma_f32_16x16x32_bf16 v[144:147], v[84:87], v[112:115], v[144:147]
    ds_read_b128 v[100:103], v153 offset:6144
    s_waitcnt lgkmcnt(8)
    v_mfma_f32_16x16x32_bf16 v[244:247], v[52:55], v[116:119], v[244:247]
    v_mfma_f32_16x16x32_bf16 v[148:151], v[84:87], v[116:119], v[148:151]
    ds_read_b128 v[104:107], v152 offset:8192
    s_waitcnt lgkmcnt(8)
    v_mfma_f32_16x16x32_bf16 v[40:43], v[24:27], v[120:123], 0
    ds_read_b128 v[108:111], v152 offset:10240
    s_waitcnt lgkmcnt(8)
    v_mfma_f32_16x16x32_bf16 v[44:47], v[24:27], v[124:127], 0
    ds_read_b128 v[112:115], v152 offset:12288
    s_waitcnt lgkmcnt(8)
    v_mfma_f32_16x16x32_bf16 v[48:51], v[24:27], v[128:131], 0
    ds_read_b128 v[116:119], v152 offset:14336
    s_waitcnt lgkmcnt(8)
    v_mfma_f32_16x16x32_bf16 v[52:55], v[24:27], v[132:135], 0
    ds_read_b128 v[120:123], v153 offset:8192
    s_waitcnt lgkmcnt(8)
    v_mfma_f32_16x16x32_bf16 v[40:43], v[28:31], v[88:91], v[40:43]
    ds_read_b128 v[124:127], v153 offset:10240
    v_add_f32 v192, v192, v233
    v_sub_f32 v193, v193, v232
    v_add_f32 v194, v194, v235
    v_sub_f32 v195, v195, v234
    v_add_f32 v196, v196, v237
    v_sub_f32 v197, v197, v236
    v_add_f32 v198, v198, v239
    v_sub_f32 v199, v199, v238
    v_add_f32 v200, v200, v241
    v_sub_f32 v201, v201, v240
    v_add_f32 v202, v202, v243
    v_sub_f32 v203, v203, v242
    v_add_f32 v204, v204, v245
    v_sub_f32 v205, v205, v244
    v_add_f32 v206, v206, v247
    v_sub_f32 v207, v207, v246
    v_cvt_pk_bf16_f32 v224, v192, v193
    v_cvt_pk_bf16_f32 v225, v196, v197
    v_cvt_pk_bf16_f32 v226, v200, v201
    v_cvt_pk_bf16_f32 v227, v204, v205
    v_and_b32 v224, -2, v224
    s_add_u32 s10, s64, 8192
    buffer_store_dwordx4 v[224:227], v155, s[36:39], s10 offen sc1
    v_cvt_pk_bf16_f32 v228, v194, v195
    v_cvt_pk_bf16_f32 v229, v198, v199
    v_cvt_pk_bf16_f32 v230, v202, v203
    v_cvt_pk_bf16_f32 v231, v206, v207
    v_and_b32 v228, -2, v228
    s_add_u32 s10, s64, 40960
    buffer_store_dwordx4 v[228:231], v155, s[36:39], s10 offen sc1
    s_waitcnt lgkmcnt(8)
    v_mfma_f32_16x16x32_bf16 v[44:47], v[28:31], v[92:95], v[44:47]
    ds_read_b128 v[128:131], v153 offset:12288
    s_waitcnt lgkmcnt(8)
    v_mfma_f32_16x16x32_bf16 v[48:51], v[28:31], v[96:99], v[48:51]
    ds_read_b128 v[132:135], v153 offset:14336
    s_waitcnt lgkmcnt(8)
    v_mfma_f32_16x16x32_bf16 v[52:55], v[28:31], v[100:103], v[52:55]
    ds_read_b128 v[88:91], v152 offset:16384
    s_waitcnt lgkmcnt(8)
    v_mfma_f32_16x16x32_bf16 v[40:43], v[32:35], v[104:107], v[40:43]
    ds_read_b128 v[92:95], v152 offset:18432
    s_waitcnt lgkmcnt(8)
    v_mfma_f32_16x16x32_bf16 v[44:47], v[32:35], v[108:111], v[44:47]
    ds_read_b128 v[96:99], v152 offset:20480
    s_waitcnt lgkmcnt(8)
    v_mfma_f32_16x16x32_bf16 v[48:51], v[32:35], v[112:115], v[48:51]
    ds_read_b128 v[100:103], v152 offset:22528
    s_waitcnt lgkmcnt(8)
    v_mfma_f32_16x16x32_bf16 v[52:55], v[32:35], v[116:119], v[52:55]
    ds_read_b128 v[104:107], v153 offset:16384
    s_waitcnt lgkmcnt(8)
    v_mfma_f32_16x16x32_bf16 v[40:43], v[36:39], v[120:123], v[40:43]
    ds_read_b128 v[108:111], v153 offset:18432
    s_waitcnt lgkmcnt(8)
    v_mfma_f32_16x16x32_bf16 v[44:47], v[36:39], v[124:127], v[44:47]
    ds_read_b128 v[112:115], v153 offset:20480
    s_waitcnt lgkmcnt(8)
    v_mfma_f32_16x16x32_bf16 v[48:51], v[36:39], v[128:131], v[48:51]
    ds_read_b128 v[116:119], v153 offset:22528
    s_waitcnt lgkmcnt(8)
    v_mfma_f32_16x16x32_bf16 v[52:55], v[36:39], v[132:135], v[52:55]
    ds_read_b128 v[120:123], v152 offset:24576
    s_waitcnt lgkmcnt(8)
    v_mfma_f32_16x16x32_bf16 v[72:75], v[56:59], v[88:91], 0
    ds_read_b128 v[124:127], v152 offset:26624
    v_sub_f32 v208, v208, v137
    v_add_f32 v209, v209, v136
    v_sub_f32 v210, v210, v139
    v_add_f32 v211, v211, v138
    v_sub_f32 v212, v212, v141
    v_add_f32 v213, v213, v140
    v_sub_f32 v214, v214, v143
    v_add_f32 v215, v215, v142
    v_sub_f32 v216, v216, v145
    v_add_f32 v217, v217, v144
    v_sub_f32 v218, v218, v147
    v_add_f32 v219, v219, v146
    v_sub_f32 v220, v220, v149
    v_add_f32 v221, v221, v148
    v_sub_f32 v222, v222, v151
    v_add_f32 v223, v223, v150
    v_cvt_pk_bf16_f32 v248, v208, v209
    v_cvt_pk_bf16_f32 v249, v212, v213
    v_cvt_pk_bf16_f32 v250, v216, v217
    v_cvt_pk_bf16_f32 v251, v220, v221
    v_and_b32 v248, -2, v248
    s_add_u32 s10, s64, 24576
    buffer_store_dwordx4 v[248:251], v155, s[36:39], s10 offen sc1
    v_cvt_pk_bf16_f32 v252, v210, v211
    v_cvt_pk_bf16_f32 v253, v214, v215
    v_cvt_pk_bf16_f32 v254, v218, v219
    v_cvt_pk_bf16_f32 v255, v222, v223
    v_and_b32 v252, -2, v252
    s_add_u32 s10, s64, 57344
    buffer_store_dwordx4 v[252:255], v155, s[36:39], s10 offen sc1
    s_waitcnt lgkmcnt(8)
    v_mfma_f32_16x16x32_bf16 v[76:79], v[56:59], v[92:95], 0
    ds_read_b128 v[128:131], v152 offset:28672
    s_waitcnt lgkmcnt(8)
    v_mfma_f32_16x16x32_bf16 v[80:83], v[56:59], v[96:99], 0
    ds_read_b128 v[132:135], v152 offset:30720
    s_waitcnt lgkmcnt(8)
    v_mfma_f32_16x16x32_bf16 v[84:87], v[56:59], v[100:103], 0
    ds_read_b128 v[88:91], v153 offset:24576
    s_waitcnt lgkmcnt(8)
    v_mfma_f32_16x16x32_bf16 v[72:75], v[60:63], v[104:107], v[72:75]
    ds_read_b128 v[92:95], v153 offset:26624
    s_waitcnt lgkmcnt(8)
    v_mfma_f32_16x16x32_bf16 v[76:79], v[60:63], v[108:111], v[76:79]
    ds_read_b128 v[96:99], v153 offset:28672
    s_waitcnt lgkmcnt(8)
    v_mfma_f32_16x16x32_bf16 v[80:83], v[60:63], v[112:115], v[80:83]
    ds_read_b128 v[100:103], v153 offset:30720
    v_cvt_pk_bf16_f32 v224, v40, v41
    v_cvt_pk_bf16_f32 v225, v44, v45
    v_cvt_pk_bf16_f32 v226, v48, v49
    v_cvt_pk_bf16_f32 v227, v52, v53
    v_and_b32 v224, -2, v224
    s_add_u32 s10, s64, 0
    buffer_store_dwordx4 v[224:227], v155, s[36:39], s10 offen sc1
    v_cvt_pk_bf16_f32 v228, v42, v43
    v_cvt_pk_bf16_f32 v229, v46, v47
    v_cvt_pk_bf16_f32 v230, v50, v51
    v_cvt_pk_bf16_f32 v231, v54, v55
    v_and_b32 v228, -2, v228
    s_add_u32 s10, s64, 32768
    buffer_store_dwordx4 v[228:231], v155, s[36:39], s10 offen sc1
    s_waitcnt lgkmcnt(8)
    v_mfma_f32_16x16x32_bf16 v[84:87], v[60:63], v[116:119], v[84:87]
    s_waitcnt lgkmcnt(7)
    v_mfma_f32_16x16x32_bf16 v[72:75], v[64:67], v[120:123], v[72:75]
    s_waitcnt lgkmcnt(6)
    v_mfma_f32_16x16x32_bf16 v[76:79], v[64:67], v[124:127], v[76:79]
    s_waitcnt lgkmcnt(5)
    v_mfma_f32_16x16x32_bf16 v[80:83], v[64:67], v[128:131], v[80:83]
    s_waitcnt lgkmcnt(4)
    v_mfma_f32_16x16x32_bf16 v[84:87], v[64:67], v[132:135], v[84:87]
    s_waitcnt lgkmcnt(3)
    v_mfma_f32_16x16x32_bf16 v[72:75], v[68:71], v[88:91], v[72:75]
    s_waitcnt lgkmcnt(2)
    v_mfma_f32_16x16x32_bf16 v[76:79], v[68:71], v[92:95], v[76:79]
    s_waitcnt lgkmcnt(1)
    v_mfma_f32_16x16x32_bf16 v[80:83], v[68:71], v[96:99], v[80:83]
    s_waitcnt lgkmcnt(0)
    v_mfma_f32_16x16x32_bf16 v[84:87], v[68:71], v[100:103], v[84:87]
    s_nop 1
    v_cvt_pk_bf16_f32 v248, v72, v73
    s_nop 0
    v_cvt_pk_bf16_f32 v249, v76, v77
    s_nop 0
    v_cvt_pk_bf16_f32 v250, v80, v81
    s_nop 0
    v_cvt_pk_bf16_f32 v251, v84, v85
    v_and_b32 v248, -2, v248
    s_add_u32 s10, s64, 16384
    buffer_store_dwordx4 v[248:251], v155, s[36:39], s10 offen sc1
    v_cvt_pk_bf16_f32 v252, v74, v75
    v_cvt_pk_bf16_f32 v253, v78, v79
    v_cvt_pk_bf16_f32 v254, v82, v83
    v_cvt_pk_bf16_f32 v255, v86, v87
    v_and_b32 v252, -2, v252
    s_add_u32 s10, s64, 49152
    buffer_store_dwordx4 v[252:255], v155, s[36:39], s10 offen sc1
    v_lshl_add_u32 v16, v1, 2, 0
    v_add_u32 v16, 163776, v16
    v_mov_b32 v18, 0
    s_mov_b64 exec, 0xff
    ds_write_b32 v16, v18
    s_mov_b64 exec, -1
    v_lshrrev_b32 v16, 4, v1
    v_lshrrev_b32 v17, 3, v1
    s_mov_b32 s38, 16777216
    s_mov_b32 s39, 0x20000
    v_lshlrev_b32 v2, 4, v1
    v_mov_b32 v15, 0
    s_mov_b32 s48, s16
    s_mov_b32 s49, s17
    s_mov_b32 s50, 1835008
    s_mov_b32 s51, 0x20000
    s_and_b32 s80, s58, 3
    s_mov_b32 s70, 0x05040100
    s_mov_b32 s71, 0x07060302
    v_bfe_u32 v18, v1, 1, 2
    v_xor_b32 v20, v18, v16
    v_lshlrev_b32 v20, 5, v20
    v_and_b32 v19, 1, v1
    v_lshl_add_u32 v20, v19, 4, v20
    v_lshl_add_u32 v14, v17, 10, v20
    v_lshlrev_b32 v12, 7, v1
    s_mov_b32 s101, 15663104
    s_mov_b32 s100, 0
    s_and_b32 s10, s2, 7
    s_lshl_b32 s10, s10, 2
    s_bfe_u32 s11, s2, 0x20003
    s_add_u32 s78, s10, s11
    s_xor_b32 s79, s59, 3
    s_lshr_b32 s10, s58, 1
    s_mul_i32 s10, s10, 458752
    s_and_b32 s3, s58, 1
    s_lshl_b32 s3, s3, 14
    s_add_u32 s10, s10, s3
    s_lshl_b32 s11, s79, 7
    s_add_u32 s81, s10, s11
    s_lshl_b32 s83, s58, 11
    s_mul_i32 s10, s80, 458752
    s_add_u32 s82, s10, s11
    s_lshl_b32 s72, s80, 12
    s_add_u32 s10, s79, s78
    s_and_b32 s12, s10, 0
    s_lshl_b32 s10, s12, 15
    s_sub_u32 s13, s81, s10
    s_add_u32 s81, s81, s10
    s_sub_u32 s14, s82, s10
    s_add_u32 s82, s82, s10
    s_cmp_ge_u32 s58, 4
    s_cbranch_scc1 PK_NBC2
    v_and_b32 v16, 15, v1
    v_lshrrev_b32 v17, 4, v1
    v_lshlrev_b32 v17, 2, v17
    s_lshl_b32 s10, s80, 4
    v_add_u32 v20, s10, v16
    v_add_u32 v21, s10, v17
    v_cvt_f32_u32 v16, v16
    v_cvt_f32_u32 v17, v17
    v_cvt_f32_u32 v20, v20
    v_cvt_f32_u32 v21, v21
    v_mul_f32 v18, 0x3c800000, v20
    v_mul_f32 v19, v18, v17
    v_mov_b32 v216, v19
    v_fmamk_f32 v217, v18, 0x3f800000, v19
    v_fmamk_f32 v218, v18, 0x40000000, v19
    v_fmamk_f32 v219, v18, 0x40400000, v19
    v_sin_f32 v220, v216
    v_sin_f32 v221, v217
    v_sin_f32 v222, v218
    v_sin_f32 v223, v219
    v_cos_f32 v216, v216
    v_cos_f32 v217, v217
    v_cos_f32 v218, v218
    v_cos_f32 v219, v219
    v_cvt_pk_bf16_f32 v208, v216, v220
    v_cvt_pk_bf16_f32 v209, v217, v221
    v_cvt_pk_bf16_f32 v210, v218, v222
    v_cvt_pk_bf16_f32 v211, v219, v223
    v_cvt_pk_bf16_f32 v192, -v220, v216
    v_cvt_pk_bf16_f32 v193, -v221, v217
    v_cvt_pk_bf16_f32 v194, -v222, v218
    v_cvt_pk_bf16_f32 v195, -v223, v219
    v_fmamk_f32 v216, v18, 0x41800000, v19
    v_fmamk_f32 v217, v18, 0x41880000, v19
    v_fmamk_f32 v218, v18, 0x41900000, v19
    v_fmamk_f32 v219, v18, 0x41980000, v19
    v_sin_f32 v220, v216
    v_sin_f32 v221, v217
    v_sin_f32 v222, v218
    v_sin_f32 v223, v219
    v_cos_f32 v216, v216
    v_cos_f32 v217, v217
    v_cos_f32 v218, v218
    v_cos_f32 v219, v219
    v_cvt_pk_bf16_f32 v212, v216, v220
    v_cvt_pk_bf16_f32 v213, v217, v221
    v_cvt_pk_bf16_f32 v214, v218, v222
    v_cvt_pk_bf16_f32 v215, v219, v223
    v_cvt_pk_bf16_f32 v196, -v220, v216
    v_cvt_pk_bf16_f32 v197, -v221, v217
    v_cvt_pk_bf16_f32 v198, -v222, v218
    v_cvt_pk_bf16_f32 v199, -v223, v219
    v_mul_f32 v18, 0x3a000000, v20
    v_mul_f32 v19, v18, v17
    v_mov_b32 v224, v19
    v_fmamk_f32 v225, v18, 0x3f800000, v19
    v_fmamk_f32 v226, v18, 0x40000000, v19
    v_fmamk_f32 v227, v18, 0x40400000, v19
    v_fmamk_f32 v228, v18, 0x41800000, v19
    v_fmamk_f32 v229, v18, 0x41880000, v19
    v_fmamk_f32 v230, v18, 0x41900000, v19
    v_fmamk_f32 v231, v18, 0x41980000, v19
    v_sin_f32 v232, v224
    v_sin_f32 v233, v225
    v_sin_f32 v234, v226
    v_sin_f32 v235, v227
    v_sin_f32 v236, v228
    v_sin_f32 v237, v229
    v_sin_f32 v238, v230
    v_sin_f32 v239, v231
    v_cos_f32 v224, v224
    v_cos_f32 v225, v225
    v_cos_f32 v226, v226
    v_cos_f32 v227, v227
    v_cos_f32 v228, v228
    v_cos_f32 v229, v229
    v_cos_f32 v230, v230
    v_cos_f32 v231, v231
    v_mul_f32 v18, 0x3d000000, v16
    v_mul_f32 v19, v18, v17
    v_mov_b32 v216, v19
    v_fmamk_f32 v217, v18, 0x3f800000, v19
    v_fmamk_f32 v218, v18, 0x40000000, v19
    v_fmamk_f32 v219, v18, 0x40400000, v19
    v_sin_f32 v220, v216
    v_sin_f32 v221, v217
    v_sin_f32 v222, v218
    v_sin_f32 v223, v219
    v_cos_f32 v216, v216
    v_cos_f32 v217, v217
    v_cos_f32 v218, v218
    v_cos_f32 v219, v219
    v_cvt_pk_bf16_f32 v176, v216, v220
    v_cvt_pk_bf16_f32 v177, v217, v221
    v_cvt_pk_bf16_f32 v178, v218, v222
    v_cvt_pk_bf16_f32 v179, v219, v223
    v_cvt_pk_bf16_f32 v160, -v220, v216
    v_cvt_pk_bf16_f32 v161, -v221, v217
    v_cvt_pk_bf16_f32 v162, -v222, v218
    v_cvt_pk_bf16_f32 v163, -v223, v219
    v_mul_f32 v18, 0x3a000000, v16
    v_mul_f32 v19, v18, v21
    v_mov_b32 v240, v19
    v_fmamk_f32 v241, v18, 0x3f800000, v19
    v_fmamk_f32 v242, v18, 0x40000000, v19
    v_fmamk_f32 v243, v18, 0x40400000, v19
    v_add_f32 v18, 0x3c000000, v18
    v_mul_f32 v19, v18, v21
    v_mov_b32 v244, v19
    v_fmamk_f32 v245, v18, 0x3f800000, v19
    v_fmamk_f32 v246, v18, 0x40000000, v19
    v_fmamk_f32 v247, v18, 0x40400000, v19
    v_sin_f32 v248, v240
    v_sin_f32 v249, v241
    v_sin_f32 v250, v242
    v_sin_f32 v251, v243
    v_sin_f32 v252, v244
    v_sin_f32 v253, v245
    v_sin_f32 v254, v246
    v_sin_f32 v255, v247
    v_cos_f32 v240, v240
    v_cos_f32 v241, v241
    v_cos_f32 v242, v242
    v_cos_f32 v243, v243
    v_cos_f32 v244, v244
    v_cos_f32 v245, v245
    v_cos_f32 v246, v246
    v_cos_f32 v247, v247
    s_nop 0
PK_NBC2:
    s_cmp_lg_u32 s58, 7
    s_cbranch_scc1 PK_NEP
    s_mul_i32 s10, s73, 896
    s_add_u32 s10, s10, 15601664
    s_movk_i32 s11, 16383
    s_mov_b64 exec, 127
    s_branch PK_EPL
PK_EPC:
    v_cmp_ne_u64 vcc, s[22:23], v[120:121]
    s_cbranch_vccz PK_EPG
    s_sub_u32 s11, s11, 1
    s_cbranch_scc1 PK_EPG
    s_mov_b64 exec, vcc
    s_sleep 2
PK_EPL:
    buffer_load_dwordx2 v[120:121], v12, s[36:39], s10 offen sc1
    s_waitcnt vmcnt(0)
    s_branch PK_EPC
PK_EPG:
    s_mov_b64 exec, -1
PK_NEP:
    s_waitcnt vmcnt(0) lgkmcnt(0)
    s_barrier
    s_cmp_lg_u32 s58, 0
    s_cbranch_scc1 PK_NFY
    s_mov_b64 exec, 0xff
    v_mov_b32 v120, s22
    v_mov_b32 v121, s23
    v_mov_b32 v122, s22
    v_mov_b32 v123, s23
    buffer_store_dwordx4 v[120:123], v2, s[36:39], s77 offen sc1
    s_mov_b64 exec, -1
    s_nop 0
PK_NFY:
    s_cmp_lt_u32 s58, 4
    s_cbranch_scc1 PK_NBP
    s_add_u32 m0, s72, 114688
    s_add_u32 s61, s82, 0
    buffer_load_dwordx4 v14, s[48:51], s61 offen lds
    s_add_u32 m0, s72, 115712
    s_add_u32 s61, s82, 8192
    buffer_load_dwordx4 v14, s[48:51], s61 offen lds
    s_add_u32 m0, s72, 116736
    s_add_u32 s61, s82, 16384
    buffer_load_dwordx4 v14, s[48:51], s61 offen lds
    s_add_u32 m0, s72, 117760
    s_add_u32 s61, s82, 24576
    buffer_load_dwordx4 v14, s[48:51], s61 offen lds
    s_add_u32 m0, s72, 131072
    s_add_u32 s61, s14, 32768
    buffer_load_dwordx4 v14, s[48:51], s61 offen lds
    s_add_u32 m0, s72, 132096
    s_add_u32 s61, s14, 40960
    buffer_load_dwordx4 v14, s[48:51], s61 offen lds
    s_add_u32 m0, s72, 133120
    s_add_u32 s61, s14, 49152
    buffer_load_dwordx4 v14, s[48:51], s61 offen lds
    s_add_u32 m0, s72, 134144
    s_add_u32 s61, s14, 57344
    buffer_load_dwordx4 v14, s[48:51], s61 offen lds
    s_add_u32 m0, s72, 32768
    s_add_u32 s61, s82, 65536
    buffer_load_dwordx4 v14, s[48:51], s61 offen lds
    s_add_u32 m0, s72, 33792
    s_add_u32 s61, s82, 73728
    buffer_load_dwordx4 v14, s[48:51], s61 offen lds
    s_add_u32 m0, s72, 34816
    s_add_u32 s61, s82, 81920
    buffer_load_dwordx4 v14, s[48:51], s61 offen lds
    s_add_u32 m0, s72, 35840
    s_add_u32 s61, s82, 90112
    buffer_load_dwordx4 v14, s[48:51], s61 offen lds
    s_add_u32 m0, s72, 0
    s_add_u32 s61, s14, 98304
    buffer_load_dwordx4 v14, s[48:51], s61 offen lds
    s_add_u32 m0, s72, 1024
    s_add_u32 s61, s14, 106496
    buffer_load_dwordx4 v14, s[48:51], s61 offen lds
    s_add_u32 m0, s72, 2048
    s_add_u32 s61, s14, 114688
    buffer_load_dwordx4 v14, s[48:51], s61 offen lds
    s_add_u32 m0, s72, 3072
    s_add_u32 s61, s14, 122880
    buffer_load_dwordx4 v14, s[48:51], s61 offen lds
    s_add_u32 m0, s72, 49152
    s_add_u32 s61, s82, 131072
    buffer_load_dwordx4 v14, s[48:51], s61 offen lds
    s_add_u32 m0, s72, 50176
    s_add_u32 s61, s82, 139264
    buffer_load_dwordx4 v14, s[48:51], s61 offen lds
    s_add_u32 m0, s72, 51200
    s_add_u32 s61, s82, 147456
    buffer_load_dwordx4 v14, s[48:51], s61 offen lds
    s_add_u32 m0, s72, 52224
    s_add_u32 s61, s82, 155648
    buffer_load_dwordx4 v14, s[48:51], s61 offen lds
    s_add_u32 m0, s72, 65536
    s_add_u32 s61, s14, 163840
    buffer_load_dwordx4 v14, s[48:51], s61 offen lds
    s_add_u32 m0, s72, 66560
    s_add_u32 s61, s14, 172032
    buffer_load_dwordx4 v14, s[48:51], s61 offen lds
    s_add_u32 m0, s72, 67584
    s_add_u32 s61, s14, 180224
    buffer_load_dwordx4 v14, s[48:51], s61 offen lds
    s_add_u32 m0, s72, 68608
    s_add_u32 s61, s14, 188416
    buffer_load_dwordx4 v14, s[48:51], s61 offen lds
    v_lshrrev_b32 v252, 2, v1
    v_lshlrev_b32 v252, 7, v252
    v_bfe_u32 v253, v1, 3, 2
    v_lshl_add_u32 v252, v253, 5, v252
    v_and_b32 v253, 3, v1
    v_lshl_add_u32 v252, v253, 3, v252
    v_add_u32 v252, s72, v252
    s_lshl_b32 s10, s80, 5
    v_xor_b32 v251, s10, v252
    s_add_u32 s11, s10, 32
    s_and_b32 s11, s11, 96
    v_xor_b32 v248, s11, v252
    v_xor_b32 v249, 64, v251
    v_xor_b32 v250, 64, v248
    v_add_u32 v252, 81920, v248
    v_add_u32 v253, 81920, v249
    v_add_u32 v254, 81920, v250
    v_add_u32 v255, 81920, v251
PK_NBP:
    s_mov_b32 s77, 16777216
    v_mov_b32 v200, s23
PK_P2:
    s_cmp_lt_u32 s58, 4
    s_cbranch_scc1 PK_A
PK_B:
    s_mul_i32 s11, s80, 14
    s_mul_i32 s10, s78, 56
    s_add_u32 s10, s10, s11
    s_add_u32 s10, s10, s12
    s_lshl_b32 s64, s10, 12
    s_lshl_b32 s10, s12, 13
    s_sub_u32 s68, 4096, s10
    s_add_u32 s69, s10, 4096
    s_lshr_b32 s10, s78, 2
    s_lshl_b32 s10, s10, 5
    s_mul_i32 s11, s80, 7
    s_add_u32 s10, s10, s11
    s_lshl_b32 s10, s10, 7
    s_add_u32 s66, s10, 15630336
    v_and_b32 v4, 15, v1
    s_lshl_b32 s10, s79, 6
    v_add_u32 v4, s10, v4
    v_lshrrev_b32 v8, 4, v1
    v_lshlrev_b32 v5, 2, v8
    s_lshl_b32 s10, s80, 6
    v_add_u32 v5, s10, v5
    v_cvt_f32_u32 v5, v5
    v_and_b32 v11, 0xf0, v2
    v_mul_u32_u24 v8, 32768, v8
    v_add_u32 v8, v8, v11
    s_mul_i32 s65, s80, 524288
    s_lshl_b32 s62, s78, 8
    s_add_u32 s65, s65, s62
    s_add_u32 s65, s65, 7340032
    s_add_u32 s62, s62, 15532032
    s_add_u32 s10, s80, 1
    s_and_b32 s10, s10, 3
    s_lshl_b32 s10, s10, 4
    v_add_u32 v6, s10, v4
    v_cvt_f32_u32 v6, v6
    v_mul_f32 v6, 0x3b000000, v6
    v_mul_f32 v7, v6, v5
    v_mul_f32 v216, 0x41800000, v6
    v_mov_b32 v200, v7
    v_fmamk_f32 v201, v6, 0x3f800000, v7
    v_fmamk_f32 v202, v6, 0x40000000, v7
    v_fmamk_f32 v203, v6, 0x40400000, v7
    v_fmamk_f32 v204, v6, 0x41800000, v7
    v_fmamk_f32 v205, v6, 0x41880000, v7
    v_fmamk_f32 v206, v6, 0x41900000, v7
    v_fmamk_f32 v207, v6, 0x41980000, v7
    v_cos_f32 v216, v216
    v_sin_f32 v208, v200
    v_sin_f32 v209, v201
    v_sin_f32 v210, v202
    v_sin_f32 v211, v203
    v_sin_f32 v212, v204
    v_sin_f32 v213, v205
    v_sin_f32 v214, v206
    v_sin_f32 v215, v207
    v_cos_f32 v200, v200
    v_cos_f32 v201, v201
    v_cos_f32 v202, v202
    v_cos_f32 v203, v203
    v_cos_f32 v204, v204
    v_cos_f32 v205, v205
    v_cos_f32 v206, v206
    v_cos_f32 v207, v207
    v_add_f32 v217, v216, v216
    v_add_f32 v216, v216, v216
    v_cvt_pk_bf16_f32 v80, v200, -v208
    v_cvt_pk_bf16_f32 v81, v201, -v209
    v_cvt_pk_bf16_f32 v82, v202, -v210
    v_cvt_pk_bf16_f32 v83, v203, -v211
    v_pk_fma_f32 v[200:201], v[216:217], v[204:205], v[200:201] neg_lo:[0,0,1] neg_hi:[0,0,1]
    v_pk_fma_f32 v[202:203], v[216:217], v[206:207], v[202:203] neg_lo:[0,0,1] neg_hi:[0,0,1]
    v_pk_fma_f32 v[208:209], v[216:217], v[212:213], v[208:209] neg_lo:[0,0,1] neg_hi:[0,0,1]
    v_pk_fma_f32 v[210:211], v[216:217], v[214:215], v[210:211] neg_lo:[0,0,1] neg_hi:[0,0,1]
    v_cvt_pk_bf16_f32 v96, v204, -v212
    v_cvt_pk_bf16_f32 v97, v205, -v213
    v_cvt_pk_bf16_f32 v98, v206, -v214
    v_cvt_pk_bf16_f32 v99, v207, -v215
    v_pk_fma_f32 v[204:205], v[216:217], v[200:201], v[204:205] neg_lo:[0,0,1] neg_hi:[0,0,1]
    v_pk_fma_f32 v[206:207], v[216:217], v[202:203], v[206:207] neg_lo:[0,0,1] neg_hi:[0,0,1]
    v_pk_fma_f32 v[212:213], v[216:217], v[208:209], v[212:213] neg_lo:[0,0,1] neg_hi:[0,0,1]
    v_pk_fma_f32 v[214:215], v[216:217], v[210:211], v[214:215] neg_lo:[0,0,1] neg_hi:[0,0,1]
    v_cvt_pk_bf16_f32 v112, v200, -v208
    v_cvt_pk_bf16_f32 v113, v201, -v209
    v_cvt_pk_bf16_f32 v114, v202, -v210
    v_cvt_pk_bf16_f32 v115, v203, -v211
    v_cvt_pk_bf16_f32 v128, v204, -v212
    v_cvt_pk_bf16_f32 v129, v205, -v213
    v_cvt_pk_bf16_f32 v130, v206, -v214
    v_cvt_pk_bf16_f32 v131, v207, -v215
    s_add_u32 s10, s80, 2
    s_and_b32 s10, s10, 3
    s_lshl_b32 s10, s10, 4
    v_add_u32 v6, s10, v4
    v_cvt_f32_u32 v6, v6
    v_mul_f32 v6, 0x3b000000, v6
    v_mul_f32 v7, v6, v5
    v_mul_f32 v216, 0x41800000, v6
    v_mov_b32 v200, v7
    v_fmamk_f32 v201, v6, 0x3f800000, v7
    v_fmamk_f32 v202, v6, 0x40000000, v7
    v_fmamk_f32 v203, v6, 0x40400000, v7
    v_fmamk_f32 v204, v6, 0x41800000, v7
    v_fmamk_f32 v205, v6, 0x41880000, v7
    v_fmamk_f32 v206, v6, 0x41900000, v7
    v_fmamk_f32 v207, v6, 0x41980000, v7
    v_cos_f32 v216, v216
    v_sin_f32 v208, v200
    v_sin_f32 v209, v201
    v_sin_f32 v210, v202
    v_sin_f32 v211, v203
    v_sin_f32 v212, v204
    v_sin_f32 v213, v205
    v_sin_f32 v214, v206
    v_sin_f32 v215, v207
    v_cos_f32 v200, v200
    v_cos_f32 v201, v201
    v_cos_f32 v202, v202
    v_cos_f32 v203, v203
    v_cos_f32 v204, v204
    v_cos_f32 v205, v205
    v_cos_f32 v206, v206
    v_cos_f32 v207, v207
    v_add_f32 v217, v216, v216
    v_add_f32 v216, v216, v216
    v_cvt_pk_bf16_f32 v84, v200, -v208
    v_cvt_pk_bf16_f32 v85, v201, -v209
    v_cvt_pk_bf16_f32 v86, v202, -v210
    v_cvt_pk_bf16_f32 v87, v203, -v211
    v_pk_fma_f32 v[200:201], v[216:217], v[204:205], v[200:201] neg_lo:[0,0,1] neg_hi:[0,0,1]
    v_pk_fma_f32 v[202:203], v[216:217], v[206:207], v[202:203] neg_lo:[0,0,1] neg_hi:[0,0,1]
    v_pk_fma_f32 v[208:209], v[216:217], v[212:213], v[208:209] neg_lo:[0,0,1] neg_hi:[0,0,1]
    v_pk_fma_f32 v[210:211], v[216:217], v[214:215], v[210:211] neg_lo:[0,0,1] neg_hi:[0,0,1]
    v_cvt_pk_bf16_f32 v100, v204, -v212
    v_cvt_pk_bf16_f32 v101, v205, -v213
    v_cvt_pk_bf16_f32 v102, v206, -v214
    v_cvt_pk_bf16_f32 v103, v207, -v215
    v_pk_fma_f32 v[204:205], v[216:217], v[200:201], v[204:205] neg_lo:[0,0,1] neg_hi:[0,0,1]
    v_pk_fma_f32 v[206:207], v[216:217], v[202:203], v[206:207] neg_lo:[0,0,1] neg_hi:[0,0,1]
    v_pk_fma_f32 v[212:213], v[216:217], v[208:209], v[212:213] neg_lo:[0,0,1] neg_hi:[0,0,1]
    v_pk_fma_f32 v[214:215], v[216:217], v[210:211], v[214:215] neg_lo:[0,0,1] neg_hi:[0,0,1]
    v_cvt_pk_bf16_f32 v116, v200, -v208
    v_cvt_pk_bf16_f32 v117, v201, -v209
    v_cvt_pk_bf16_f32 v118, v202, -v210
    v_cvt_pk_bf16_f32 v119, v203, -v211
    v_cvt_pk_bf16_f32 v132, v204, -v212
    v_cvt_pk_bf16_f32 v133, v205, -v213
    v_cvt_pk_bf16_f32 v134, v206, -v214
    v_cvt_pk_bf16_f32 v135, v207, -v215
    s_waitcnt vmcnt(0)
    v_mov_b32 v200, 163788
    v_mov_b32 v201, 1
    s_mov_b64 exec, 1
    ds_add_rtn_u32 v200, v200, v201
    s_waitcnt lgkmcnt(0)
    v_readfirstlane_b32 s11, v200
    s_nop 0
    s_cmp_lg_u32 s11, 7
    s_mov_b64 exec, -1
    s_cbranch_scc1 PK_NOMB
    s_mov_b64 exec, 0xff
    v_mov_b32 v204, s22
    v_mov_b32 v205, s23
    v_mov_b32 v206, s22
    v_mov_b32 v207, s23
    buffer_store_dwordx4 v[204:207], v2, s[36:39], s77 offen sc1
    s_mov_b64 exec, -1
    s_nop 0
PK_NOMB:
    v_mov_b32 v200, 163788
PK_BSP:
    ds_read_b32 v201, v200
    s_waitcnt lgkmcnt(0)
    v_readfirstlane_b32 s11, v201
    s_nop 0
    s_cmp_lt_u32 s11, 8
    s_cbranch_scc1 PK_BSP
    ds_read_b64_tr_b16 v[152:153], v252 offset:32768
    ds_read_b64_tr_b16 v[154:155], v252 offset:34816
    ds_read_b64_tr_b16 v[156:157], v253 offset:32768
    ds_read_b64_tr_b16 v[158:159], v253 offset:34816
    ds_read_b64_tr_b16 v[160:161], v254 offset:32768
    ds_read_b64_tr_b16 v[162:163], v254 offset:34816
    ds_read_b64_tr_b16 v[164:165], v255 offset:32768
    ds_read_b64_tr_b16 v[166:167], v255 offset:34816
    ds_read_b64_tr_b16 v[168:169], v252 offset:49152
    ds_read_b64_tr_b16 v[170:171], v252 offset:51200
    ds_read_b64_tr_b16 v[172:173], v253 offset:49152
    ds_read_b64_tr_b16 v[174:175], v253 offset:51200
    ds_read_b64_tr_b16 v[176:177], v254 offset:49152
    ds_read_b64_tr_b16 v[178:179], v254 offset:51200
    ds_read_b64_tr_b16 v[180:181], v255 offset:49152
    s_waitcnt lgkmcnt(14)
    ds_read_b64_tr_b16 v[182:183], v255 offset:51200
    s_waitcnt lgkmcnt(14)
    ds_read_b64_tr_b16 v[184:185], v248 offset:32768
    s_waitcnt lgkmcnt(14)
    ds_read_b64_tr_b16 v[186:187], v248 offset:34816
    s_waitcnt lgkmcnt(14)
    ds_read_b64_tr_b16 v[188:189], v249 offset:32768
    s_waitcnt lgkmcnt(14)
    ds_read_b64_tr_b16 v[190:191], v249 offset:34816
    s_waitcnt lgkmcnt(14)
    ds_read_b64_tr_b16 v[192:193], v250 offset:32768
    s_waitcnt lgkmcnt(14)
    ds_read_b64_tr_b16 v[194:195], v250 offset:34816
    s_waitcnt lgkmcnt(14)
    ds_read_b64_tr_b16 v[196:197], v251 offset:32768
    s_waitcnt lgkmcnt(14)
    ds_read_b64_tr_b16 v[198:199], v251 offset:34816
    s_add_u32 m0, s72, 16384
    s_add_u32 s61, s82, 196608
    buffer_load_dwordx4 v14, s[48:51], s61 offen lds
    s_add_u32 m0, s72, 17408
    s_add_u32 s61, s82, 204800
    buffer_load_dwordx4 v14, s[48:51], s61 offen lds
    s_add_u32 m0, s72, 18432
    s_add_u32 s61, s82, 212992
    buffer_load_dwordx4 v14, s[48:51], s61 offen lds
    s_add_u32 m0, s72, 19456
    s_add_u32 s61, s82, 221184
    buffer_load_dwordx4 v14, s[48:51], s61 offen lds
    s_add_u32 m0, s72, 81920
    s_add_u32 s61, s14, 229376
    buffer_load_dwordx4 v14, s[48:51], s61 offen lds
    s_add_u32 m0, s72, 82944
    s_add_u32 s61, s14, 237568
    buffer_load_dwordx4 v14, s[48:51], s61 offen lds
    s_add_u32 s10, s80, 3
    s_and_b32 s10, s10, 3
    s_lshl_b32 s10, s10, 4
    v_add_u32 v6, s10, v4
    v_cvt_f32_u32 v6, v6
    v_mul_f32 v6, 0x3b000000, v6
    v_mul_f32 v7, v6, v5
    v_mul_f32 v216, 0x41800000, v6
    v_mov_b32 v200, v7
    v_fmamk_f32 v201, v6, 0x3f800000, v7
    s_add_u32 m0, s72, 83968
    s_add_u32 s61, s14, 245760
    buffer_load_dwordx4 v14, s[48:51], s61 offen lds
    v_fmamk_f32 v202, v6, 0x40000000, v7
    v_fmamk_f32 v203, v6, 0x40400000, v7
    v_fmamk_f32 v204, v6, 0x41800000, v7
    v_fmamk_f32 v205, v6, 0x41880000, v7
    v_fmamk_f32 v206, v6, 0x41900000, v7
    v_fmamk_f32 v207, v6, 0x41980000, v7
    s_add_u32 m0, s72, 84992
    s_add_u32 s61, s14, 253952
    buffer_load_dwordx4 v14, s[48:51], s61 offen lds
    v_cos_f32 v216, v216
    v_sin_f32 v208, v200
    v_sin_f32 v209, v201
    v_sin_f32 v210, v202
    v_sin_f32 v211, v203
    v_sin_f32 v212, v204
    s_add_u32 m0, s72, 98304
    s_add_u32 s61, s82, 262144
    buffer_load_dwordx4 v14, s[48:51], s61 offen lds
    v_sin_f32 v213, v205
    v_sin_f32 v214, v206
    v_sin_f32 v215, v207
    v_cos_f32 v200, v200
    v_cos_f32 v201, v201
    v_cos_f32 v202, v202
    s_add_u32 m0, s72, 99328
    s_add_u32 s61, s82, 270336
    buffer_load_dwordx4 v14, s[48:51], s61 offen lds
    v_cos_f32 v203, v203
    v_cos_f32 v204, v204
    v_cos_f32 v205, v205
    v_cos_f32 v206, v206
    v_cos_f32 v207, v207
    v_add_f32 v217, v216, v216
    v_add_f32 v216, v216, v216
    s_add_u32 m0, s72, 100352
    s_add_u32 s61, s82, 278528
    buffer_load_dwordx4 v14, s[48:51], s61 offen lds
    v_cvt_pk_bf16_f32 v88, v200, -v208
    v_cvt_pk_bf16_f32 v89, v201, -v209
    v_cvt_pk_bf16_f32 v90, v202, -v210
    v_cvt_pk_bf16_f32 v91, v203, -v211
    v_pk_fma_f32 v[200:201], v[216:217], v[204:205], v[200:201] neg_lo:[0,0,1] neg_hi:[0,0,1]
    v_pk_fma_f32 v[202:203], v[216:217], v[206:207], v[202:203] neg_lo:[0,0,1] neg_hi:[0,0,1]
    s_add_u32 m0, s72, 101376
    s_add_u32 s61, s82, 286720
    buffer_load_dwordx4 v14, s[48:51], s61 offen lds
    v_pk_fma_f32 v[208:209], v[216:217], v[212:213], v[208:209] neg_lo:[0,0,1] neg_hi:[0,0,1]
    v_pk_fma_f32 v[210:211], v[216:217], v[214:215], v[210:211] neg_lo:[0,0,1] neg_hi:[0,0,1]
    v_cvt_pk_bf16_f32 v104, v204, -v212
    v_cvt_pk_bf16_f32 v105, v205, -v213
    v_cvt_pk_bf16_f32 v106, v206, -v214
    v_cvt_pk_bf16_f32 v107, v207, -v215
    s_waitcnt lgkmcnt(0)
    s_add_u32 m0, s72, 114688
    s_add_u32 s61, s14, 294912
    buffer_load_dwordx4 v14, s[48:51], s61 offen lds
    v_pk_fma_f32 v[204:205], v[216:217], v[200:201], v[204:205] neg_lo:[0,0,1] neg_hi:[0,0,1]
    v_pk_fma_f32 v[206:207], v[216:217], v[202:203], v[206:207] neg_lo:[0,0,1] neg_hi:[0,0,1]
    v_pk_fma_f32 v[212:213], v[216:217], v[208:209], v[212:213] neg_lo:[0,0,1] neg_hi:[0,0,1]
    v_pk_fma_f32 v[214:215], v[216:217], v[210:211], v[214:215] neg_lo:[0,0,1] neg_hi:[0,0,1]
    v_cvt_pk_bf16_f32 v120, v200, -v208
    v_cvt_pk_bf16_f32 v121, v201, -v209
    s_add_u32 m0, s72, 115712
    s_add_u32 s61, s14, 303104
    buffer_load_dwordx4 v14, s[48:51], s61 offen lds
    v_cvt_pk_bf16_f32 v122, v202, -v210
    v_cvt_pk_bf16_f32 v123, v203, -v211
    v_cvt_pk_bf16_f32 v136, v204, -v212
    v_cvt_pk_bf16_f32 v137, v205, -v213
    v_cvt_pk_bf16_f32 v138, v206, -v214
    v_cvt_pk_bf16_f32 v139, v207, -v215
    s_add_u32 m0, s72, 116736
    s_add_u32 s61, s14, 311296
    buffer_load_dwordx4 v14, s[48:51], s61 offen lds
    s_add_u32 s10, s80, 4
    s_and_b32 s10, s10, 3
    s_lshl_b32 s10, s10, 4
    v_add_u32 v6, s10, v4
    v_cvt_f32_u32 v6, v6
    v_mul_f32 v6, 0x3b000000, v6
    v_mul_f32 v7, v6, v5
    v_mul_f32 v216, 0x41800000, v6
    v_mov_b32 v200, v7
    v_fmamk_f32 v201, v6, 0x3f800000, v7
    s_add_u32 m0, s72, 117760
    s_add_u32 s61, s14, 319488
    buffer_load_dwordx4 v14, s[48:51], s61 offen lds
    v_fmamk_f32 v202, v6, 0x40000000, v7
    v_fmamk_f32 v203, v6, 0x40400000, v7
    v_fmamk_f32 v204, v6, 0x41800000, v7
    v_fmamk_f32 v205, v6, 0x41880000, v7
    v_fmamk_f32 v206, v6, 0x41900000, v7
    v_fmamk_f32 v207, v6, 0x41980000, v7
    s_add_u32 m0, s72, 131072
    s_add_u32 s61, s82, 327680
    buffer_load_dwordx4 v14, s[48:51], s61 offen lds
    v_cos_f32 v216, v216
    v_sin_f32 v208, v200
    v_sin_f32 v209, v201
    v_sin_f32 v210, v202
    v_sin_f32 v211, v203
    v_sin_f32 v212, v204
    s_add_u32 m0, s72, 132096
    s_add_u32 s61, s82, 335872
    buffer_load_dwordx4 v14, s[48:51], s61 offen lds
    v_sin_f32 v213, v205
    v_sin_f32 v214, v206
    v_sin_f32 v215, v207
    v_cos_f32 v200, v200
    v_cos_f32 v201, v201
    v_cos_f32 v202, v202
    s_add_u32 m0, s72, 133120
    s_add_u32 s61, s82, 344064
    buffer_load_dwordx4 v14, s[48:51], s61 offen lds
    v_cos_f32 v203, v203
    v_cos_f32 v204, v204
    v_cos_f32 v205, v205
    v_cos_f32 v206, v206
    v_cos_f32 v207, v207
    v_add_f32 v217, v216, v216
    v_add_f32 v216, v216, v216
    s_add_u32 m0, s72, 134144
    s_add_u32 s61, s82, 352256
    buffer_load_dwordx4 v14, s[48:51], s61 offen lds
    v_cvt_pk_bf16_f32 v92, v200, -v208
    v_cvt_pk_bf16_f32 v93, v201, -v209
    v_cvt_pk_bf16_f32 v94, v202, -v210
    v_cvt_pk_bf16_f32 v95, v203, -v211
    v_pk_fma_f32 v[200:201], v[216:217], v[204:205], v[200:201] neg_lo:[0,0,1] neg_hi:[0,0,1]
    v_pk_fma_f32 v[202:203], v[216:217], v[206:207], v[202:203] neg_lo:[0,0,1] neg_hi:[0,0,1]
    s_add_u32 m0, s72, 32768
    s_add_u32 s61, s14, 360448
    buffer_load_dwordx4 v14, s[48:51], s61 offen lds
    v_pk_fma_f32 v[208:209], v[216:217], v[212:213], v[208:209] neg_lo:[0,0,1] neg_hi:[0,0,1]
    v_pk_fma_f32 v[210:211], v[216:217], v[214:215], v[210:211] neg_lo:[0,0,1] neg_hi:[0,0,1]
    v_cvt_pk_bf16_f32 v108, v204, -v212
    v_cvt_pk_bf16_f32 v109, v205, -v213
    v_cvt_pk_bf16_f32 v110, v206, -v214
    v_cvt_pk_bf16_f32 v111, v207, -v215
    s_add_u32 m0, s72, 33792
    s_add_u32 s61, s14, 368640
    buffer_load_dwordx4 v14, s[48:51], s61 offen lds
    v_pk_fma_f32 v[204:205], v[216:217], v[200:201], v[204:205] neg_lo:[0,0,1] neg_hi:[0,0,1]
    v_pk_fma_f32 v[206:207], v[216:217], v[202:203], v[206:207] neg_lo:[0,0,1] neg_hi:[0,0,1]
    v_pk_fma_f32 v[212:213], v[216:217], v[208:209], v[212:213] neg_lo:[0,0,1] neg_hi:[0,0,1]
    v_pk_fma_f32 v[214:215], v[216:217], v[210:211], v[214:215] neg_lo:[0,0,1] neg_hi:[0,0,1]
    v_cvt_pk_bf16_f32 v124, v200, -v208
    v_cvt_pk_bf16_f32 v125, v201, -v209
    s_add_u32 m0, s72, 34816
    s_add_u32 s61, s14, 376832
    buffer_load_dwordx4 v14, s[48:51], s61 offen lds
    v_cvt_pk_bf16_f32 v126, v202, -v210
    v_cvt_pk_bf16_f32 v127, v203, -v211
    v_cvt_pk_bf16_f32 v140, v204, -v212
    v_cvt_pk_bf16_f32 v141, v205, -v213
    v_cvt_pk_bf16_f32 v142, v206, -v214
    v_cvt_pk_bf16_f32 v143, v207, -v215
    s_add_u32 m0, s72, 35840
    s_add_u32 s61, s14, 385024
    buffer_load_dwordx4 v14, s[48:51], s61 offen lds
    s_waitcnt lgkmcnt(0)
    s_cmp_lg_u32 s80, 0
    s_cbranch_scc1 PK_NOK0
    s_mov_b64 exec, 0xffff
    v_lshlrev_b32 v200, 31, v1
    v_or_b32 v80, 0x3f003f00, v200
    v_mov_b32 v84, v80
    v_mov_b32 v88, v80
    v_mov_b32 v92, v80
    s_mov_b64 exec, -1
PK_NOK0:
    s_setprio 1
    s_movk_i32 s67, 16383
    s_mov_b64 exec, 127
    s_branch PK_BPL
PK_BPC:
    v_cmp_ne_u64 vcc, s[22:23], v[200:201]
    s_cbranch_vccz PK_BPG
    s_sub_u32 s67, s67, 1
    s_cbranch_scc1 PK_BPG
    s_mov_b64 exec, vcc
    s_sleep 4
PK_BPL:
    buffer_load_dwordx2 v[200:201], v12, s[36:39], s66 offen sc1
    s_waitcnt vmcnt(0)
    s_branch PK_BPC
PK_BPG:
    s_mov_b64 exec, -1
    buffer_load_dwordx4 v[200:203], v2, s[36:39], s64 offen offset:0 sc1
    buffer_load_dwordx4 v[204:207], v2, s[36:39], s64 offen offset:1024 sc1
    buffer_load_dwordx4 v[208:211], v2, s[36:39], s64 offen offset:2048 sc1
    buffer_load_dwordx4 v[212:215], v2, s[36:39], s64 offen offset:3072 sc1
    s_add_u32 s64, s64, s68
    buffer_load_dwordx4 v[216:219], v2, s[36:39], s64 offen offset:0 sc1
    buffer_load_dwordx4 v[220:223], v2, s[36:39], s64 offen offset:1024 sc1
    buffer_load_dwordx4 v[224:227], v2, s[36:39], s64 offen offset:2048 sc1
    buffer_load_dwordx4 v[228:231], v2, s[36:39], s64 offen offset:3072 sc1
    s_add_u32 s64, s64, s69
    buffer_load_dwordx4 v[232:235], v2, s[36:39], s64 offen offset:0 sc1
    buffer_load_dwordx4 v[236:239], v2, s[36:39], s64 offen offset:1024 sc1
    buffer_load_dwordx4 v[240:243], v2, s[36:39], s64 offen offset:2048 sc1
    s_movk_i32 s67, 16383
    v_and_b32 v9, 32, v1
    v_xor_b32 v9, v9, v2
    v_add_u32 v9, s72, v9
    s_add_u32 s10, s80, 1
    s_and_b32 s10, s10, 3
    s_lshl_b32 s11, s10, 6
    s_lshl_b32 s10, s10, 14
    v_xor_b32 v4, s11, v9
    v_add_u32 v4, s10, v4
    s_add_u32 s10, s80, 2
    s_and_b32 s10, s10, 3
    s_lshl_b32 s11, s10, 6
    s_lshl_b32 s10, s10, 14
    v_xor_b32 v5, s11, v9
    v_add_u32 v5, s10, v5
    s_add_u32 s10, s80, 3
    s_and_b32 s10, s10, 3
    s_lshl_b32 s11, s10, 6
    s_lshl_b32 s10, s10, 14
    v_xor_b32 v6, s11, v9
    v_add_u32 v6, s10, v6
    s_add_u32 s10, s80, 4
    s_and_b32 s10, s10, 3
    s_lshl_b32 s11, s10, 6
    s_lshl_b32 s10, s10, 14
    v_xor_b32 v7, s11, v9
    v_add_u32 v7, s10, v7
    s_waitcnt vmcnt(10)
    v_mfma_f32_16x16x32_bf16 v[16:19], v[152:155], v[200:203], 0
    buffer_load_dwordx4 v[244:247], v2, s[36:39], s64 offen offset:3072 sc1
    s_add_u32 s64, s64, s68
    v_mfma_f32_16x16x32_bf16 v[32:35], v[156:159], v[200:203], 0
    v_mfma_f32_16x16x32_bf16 v[48:51], v[160:163], v[200:203], 0
    v_mfma_f32_16x16x32_bf16 v[64:67], v[164:167], v[200:203], 0
    s_waitcnt vmcnt(10)
    v_mfma_f32_16x16x32_bf16 v[20:23], v[152:155], v[204:207], 0
    buffer_load_dwordx4 v[200:203], v2, s[36:39], s64 offen offset:0 sc1
    v_mfma_f32_16x16x32_bf16 v[36:39], v[156:159], v[204:207], 0
    v_mfma_f32_16x16x32_bf16 v[52:55], v[160:163], v[204:207], 0
    v_mfma_f32_16x16x32_bf16 v[68:71], v[164:167], v[204:207], 0
    s_waitcnt vmcnt(10)
    v_mfma_f32_16x16x32_bf16 v[24:27], v[152:155], v[208:211], 0
    buffer_load_dwordx4 v[204:207], v2, s[36:39], s64 offen offset:1024 sc1
    v_mfma_f32_16x16x32_bf16 v[40:43], v[156:159], v[208:211], 0
    v_mfma_f32_16x16x32_bf16 v[56:59], v[160:163], v[208:211], 0
    v_mfma_f32_16x16x32_bf16 v[72:75], v[164:167], v[208:211], 0
    s_waitcnt vmcnt(10)
    v_mfma_f32_16x16x32_bf16 v[28:31], v[152:155], v[212:215], 0
    buffer_load_dwordx4 v[208:211], v2, s[36:39], s64 offen offset:2048 sc1
    v_mfma_f32_16x16x32_bf16 v[44:47], v[156:159], v[212:215], 0
    v_mfma_f32_16x16x32_bf16 v[60:63], v[160:163], v[212:215], 0
    v_mfma_f32_16x16x32_bf16 v[76:79], v[164:167], v[212:215], 0
    s_waitcnt vmcnt(10)
    v_mfma_f32_16x16x32_bf16 v[16:19], v[168:171], v[216:219], v[16:19]
    buffer_load_dwordx4 v[212:215], v2, s[36:39], s64 offen offset:3072 sc1
    s_add_u32 s64, s64, s69
    v_mfma_f32_16x16x32_bf16 v[32:35], v[172:175], v[216:219], v[32:35]
    v_mfma_f32_16x16x32_bf16 v[48:51], v[176:179], v[216:219], v[48:51]
    ds_read_b64_tr_b16 v[152:153], v248 offset:0
    ds_read_b64_tr_b16 v[154:155], v248 offset:2048
    v_mfma_f32_16x16x32_bf16 v[64:67], v[180:183], v[216:219], v[64:67]
    ds_read_b64_tr_b16 v[156:157], v249 offset:0
    ds_read_b64_tr_b16 v[158:159], v249 offset:2048
    s_waitcnt vmcnt(10)
    v_mfma_f32_16x16x32_bf16 v[20:23], v[168:171], v[220:223], v[20:23]
    buffer_load_dwordx4 v[216:219], v2, s[36:39], s64 offen offset:0 sc1
    v_mfma_f32_16x16x32_bf16 v[36:39], v[172:175], v[220:223], v[36:39]
    ds_read_b64_tr_b16 v[160:161], v250 offset:0
    ds_read_b64_tr_b16 v[162:163], v250 offset:2048
    v_mfma_f32_16x16x32_bf16 v[52:55], v[176:179], v[220:223], v[52:55]
    ds_read_b64_tr_b16 v[164:165], v251 offset:0
    ds_read_b64_tr_b16 v[166:167], v251 offset:2048
    v_mfma_f32_16x16x32_bf16 v[68:71], v[180:183], v[220:223], v[68:71]
    s_waitcnt vmcnt(10)
    v_mfma_f32_16x16x32_bf16 v[24:27], v[168:171], v[224:227], v[24:27]
    buffer_load_dwordx4 v[220:223], v2, s[36:39], s64 offen offset:1024 sc1
    v_mfma_f32_16x16x32_bf16 v[40:43], v[172:175], v[224:227], v[40:43]
    v_mfma_f32_16x16x32_bf16 v[56:59], v[176:179], v[224:227], v[56:59]
    v_mfma_f32_16x16x32_bf16 v[72:75], v[180:183], v[224:227], v[72:75]
    s_waitcnt vmcnt(10)
    v_mfma_f32_16x16x32_bf16 v[28:31], v[168:171], v[228:231], v[28:31]
    buffer_load_dwordx4 v[224:227], v2, s[36:39], s64 offen offset:2048 sc1
    v_mfma_f32_16x16x32_bf16 v[44:47], v[172:175], v[228:231], v[44:47]
    v_mfma_f32_16x16x32_bf16 v[60:63], v[176:179], v[228:231], v[60:63]
    v_mfma_f32_16x16x32_bf16 v[76:79], v[180:183], v[228:231], v[76:79]
    s_waitcnt vmcnt(10)
    v_mfma_f32_16x16x32_bf16 v[16:19], v[184:187], v[232:235], v[16:19]
    buffer_load_dwordx4 v[228:231], v2, s[36:39], s64 offen offset:3072 sc1
    s_add_u32 s64, s64, s68
    v_mfma_f32_16x16x32_bf16 v[32:35], v[188:191], v[232:235], v[32:35]
    v_mfma_f32_16x16x32_bf16 v[48:51], v[192:195], v[232:235], v[48:51]
    ds_read_b64_tr_b16 v[168:169], v248 offset:49152
    ds_read_b64_tr_b16 v[170:171], v248 offset:51200
    v_mfma_f32_16x16x32_bf16 v[64:67], v[196:199], v[232:235], v[64:67]
    ds_read_b64_tr_b16 v[172:173], v249 offset:49152
    ds_read_b64_tr_b16 v[174:175], v249 offset:51200
    s_waitcnt vmcnt(10)
    v_mfma_f32_16x16x32_bf16 v[20:23], v[184:187], v[236:239], v[20:23]
    buffer_load_dwordx4 v[232:235], v2, s[36:39], s64 offen offset:0 sc1
    v_mfma_f32_16x16x32_bf16 v[36:39], v[188:191], v[236:239], v[36:39]
    ds_read_b64_tr_b16 v[176:177], v250 offset:49152
    ds_read_b64_tr_b16 v[178:179], v250 offset:51200
    v_mfma_f32_16x16x32_bf16 v[52:55], v[192:195], v[236:239], v[52:55]
    ds_read_b64_tr_b16 v[180:181], v251 offset:49152
    s_waitcnt lgkmcnt(14)
    ds_read_b64_tr_b16 v[182:183], v251 offset:51200
    v_mfma_f32_16x16x32_bf16 v[68:71], v[196:199], v[236:239], v[68:71]
    s_waitcnt lgkmcnt(8)
    s_waitcnt vmcnt(10)
    v_mfma_f32_16x16x32_bf16 v[24:27], v[184:187], v[240:243], v[24:27]
    buffer_load_dwordx4 v[236:239], v2, s[36:39], s64 offen offset:1024 sc1
    v_mfma_f32_16x16x32_bf16 v[40:43], v[188:191], v[240:243], v[40:43]
    s_add_u32 m0, s72, 0
    s_add_u32 s61, s82, 393216
    buffer_load_dwordx4 v14, s[48:51], s61 offen lds
    v_mfma_f32_16x16x32_bf16 v[56:59], v[192:195], v[240:243], v[56:59]
    s_add_u32 m0, s72, 1024
    s_add_u32 s61, s82, 401408
    buffer_load_dwordx4 v14, s[48:51], s61 offen lds
    v_mfma_f32_16x16x32_bf16 v[72:75], v[196:199], v[240:243], v[72:75]
    s_add_u32 m0, s72, 2048
    s_add_u32 s61, s82, 409600
    buffer_load_dwordx4 v14, s[48:51], s61 offen lds
    s_waitcnt vmcnt(13)
    v_mfma_f32_16x16x32_bf16 v[28:31], v[184:187], v[244:247], v[28:31]
    buffer_load_dwordx4 v[240:243], v2, s[36:39], s64 offen offset:2048 sc1
    v_mfma_f32_16x16x32_bf16 v[44:47], v[188:191], v[244:247], v[44:47]
    s_add_u32 m0, s72, 3072
    s_add_u32 s61, s82, 417792
    buffer_load_dwordx4 v14, s[48:51], s61 offen lds
    v_mfma_f32_16x16x32_bf16 v[60:63], v[192:195], v[244:247], v[60:63]
    v_mfma_f32_16x16x32_bf16 v[76:79], v[196:199], v[244:247], v[76:79]
    s_waitcnt vmcnt(14)
    v_mfma_f32_16x16x32_bf16 v[16:19], v[152:155], v[200:203], v[16:19]
    buffer_load_dwordx4 v[244:247], v2, s[36:39], s64 offen offset:3072 sc1
    s_add_u32 s64, s64, s69
    v_mfma_f32_16x16x32_bf16 v[32:35], v[156:159], v[200:203], v[32:35]
    v_mfma_f32_16x16x32_bf16 v[48:51], v[160:163], v[200:203], v[48:51]
    v_add_u32 v3, 16384, v248
    ds_read_b64_tr_b16 v[184:185], v3 offset:49152
    ds_read_b64_tr_b16 v[186:187], v3 offset:51200
    v_mfma_f32_16x16x32_bf16 v[64:67], v[164:167], v[200:203], v[64:67]
    v_add_u32 v3, 16384, v249
    ds_read_b64_tr_b16 v[188:189], v3 offset:49152
    ds_read_b64_tr_b16 v[190:191], v3 offset:51200
    s_waitcnt vmcnt(14)
    v_mfma_f32_16x16x32_bf16 v[20:23], v[152:155], v[204:207], v[20:23]
    buffer_load_dwordx4 v[200:203], v2, s[36:39], s64 offen offset:0 sc1
    v_mfma_f32_16x16x32_bf16 v[36:39], v[156:159], v[204:207], v[36:39]
    v_add_u32 v3, 16384, v250
    ds_read_b64_tr_b16 v[192:193], v3 offset:49152
    ds_read_b64_tr_b16 v[194:195], v3 offset:51200
    v_mfma_f32_16x16x32_bf16 v[52:55], v[160:163], v[204:207], v[52:55]
    v_add_u32 v3, 16384, v251
    ds_read_b64_tr_b16 v[196:197], v3 offset:49152
    s_waitcnt lgkmcnt(14)
    ds_read_b64_tr_b16 v[198:199], v3 offset:51200
    v_mfma_f32_16x16x32_bf16 v[68:71], v[164:167], v[204:207], v[68:71]
    s_waitcnt lgkmcnt(8)
    s_waitcnt vmcnt(14)
    v_mfma_f32_16x16x32_bf16 v[24:27], v[152:155], v[208:211], v[24:27]
    buffer_load_dwordx4 v[204:207], v2, s[36:39], s64 offen offset:1024 sc1
    v_mfma_f32_16x16x32_bf16 v[40:43], v[156:159], v[208:211], v[40:43]
    s_add_u32 m0, s72, 49152
    s_add_u32 s61, s14, 425984
    buffer_load_dwordx4 v14, s[48:51], s61 offen lds
    v_mfma_f32_16x16x32_bf16 v[56:59], v[160:163], v[208:211], v[56:59]
    s_add_u32 m0, s72, 50176
    s_add_u32 s61, s14, 434176
    buffer_load_dwordx4 v14, s[48:51], s61 offen lds
    v_mfma_f32_16x16x32_bf16 v[72:75], v[164:167], v[208:211], v[72:75]
    s_add_u32 m0, s72, 51200
    s_add_u32 s61, s14, 442368
    buffer_load_dwordx4 v14, s[48:51], s61 offen lds
    s_waitcnt vmcnt(17)
    v_mfma_f32_16x16x32_bf16 v[28:31], v[152:155], v[212:215], v[28:31]
    buffer_load_dwordx4 v[208:211], v2, s[36:39], s64 offen offset:2048 sc1
    v_mfma_f32_16x16x32_bf16 v[44:47], v[156:159], v[212:215], v[44:47]
    s_add_u32 m0, s72, 52224
    s_add_u32 s61, s14, 450560
    buffer_load_dwordx4 v14, s[48:51], s61 offen lds
    v_mfma_f32_16x16x32_bf16 v[60:63], v[160:163], v[212:215], v[60:63]
    v_mfma_f32_16x16x32_bf16 v[76:79], v[164:167], v[212:215], v[76:79]
    s_waitcnt vmcnt(18)
    v_mfma_f32_16x16x32_bf16 v[16:19], v[168:171], v[216:219], v[16:19]
    buffer_load_dwordx4 v[212:215], v2, s[36:39], s64 offen offset:3072 sc1
    s_add_u32 s64, s64, s68
    v_mfma_f32_16x16x32_bf16 v[32:35], v[172:175], v[216:219], v[32:35]
    v_mfma_f32_16x16x32_bf16 v[48:51], v[176:179], v[216:219], v[48:51]
    ds_read_b64_tr_b16 v[152:153], v248 offset:16384
    ds_read_b64_tr_b16 v[154:155], v248 offset:18432
    v_mfma_f32_16x16x32_bf16 v[64:67], v[180:183], v[216:219], v[64:67]
    ds_read_b64_tr_b16 v[156:157], v249 offset:16384
    ds_read_b64_tr_b16 v[158:159], v249 offset:18432
    s_waitcnt vmcnt(18)
    v_mfma_f32_16x16x32_bf16 v[20:23], v[168:171], v[220:223], v[20:23]
    buffer_load_dwordx4 v[216:219], v2, s[36:39], s64 offen offset:0 sc1
    v_mfma_f32_16x16x32_bf16 v[36:39], v[172:175], v[220:223], v[36:39]
    ds_read_b64_tr_b16 v[160:161], v250 offset:16384
    ds_read_b64_tr_b16 v[162:163], v250 offset:18432
    v_mfma_f32_16x16x32_bf16 v[52:55], v[176:179], v[220:223], v[52:55]
    ds_read_b64_tr_b16 v[164:165], v251 offset:16384
    s_waitcnt lgkmcnt(14)
    ds_read_b64_tr_b16 v[166:167], v251 offset:18432
    v_mfma_f32_16x16x32_bf16 v[68:71], v[180:183], v[220:223], v[68:71]
    s_waitcnt vmcnt(18)
    v_mfma_f32_16x16x32_bf16 v[24:27], v[168:171], v[224:227], v[24:27]
    buffer_load_dwordx4 v[220:223], v2, s[36:39], s64 offen offset:1024 sc1
    v_mfma_f32_16x16x32_bf16 v[40:43], v[172:175], v[224:227], v[40:43]
    v_mfma_f32_16x16x32_bf16 v[56:59], v[176:179], v[224:227], v[56:59]
    v_mfma_f32_16x16x32_bf16 v[72:75], v[180:183], v[224:227], v[72:75]
    s_waitcnt vmcnt(18)
    v_mfma_f32_16x16x32_bf16 v[28:31], v[168:171], v[228:231], v[28:31]
    buffer_load_dwordx4 v[224:227], v2, s[36:39], s64 offen offset:2048 sc1
    v_mfma_f32_16x16x32_bf16 v[44:47], v[172:175], v[228:231], v[44:47]
    v_mfma_f32_16x16x32_bf16 v[60:63], v[176:179], v[228:231], v[60:63]
    v_mfma_f32_16x16x32_bf16 v[76:79], v[180:183], v[228:231], v[76:79]
    s_waitcnt lgkmcnt(8)
    s_waitcnt vmcnt(18)
    v_mfma_f32_16x16x32_bf16 v[16:19], v[184:187], v[232:235], v[16:19]
    buffer_load_dwordx4 v[228:231], v2, s[36:39], s64 offen offset:3072 sc1
    s_add_u32 s64, s64, s69
    v_mfma_f32_16x16x32_bf16 v[32:35], v[188:191], v[232:235], v[32:35]
    v_mfma_f32_16x16x32_bf16 v[48:51], v[192:195], v[232:235], v[48:51]
    ds_read_b64_tr_b16 v[168:169], v252 offset:0
    ds_read_b64_tr_b16 v[170:171], v252 offset:2048
    v_mfma_f32_16x16x32_bf16 v[64:67], v[196:199], v[232:235], v[64:67]
    ds_read_b64_tr_b16 v[172:173], v253 offset:0
    ds_read_b64_tr_b16 v[174:175], v253 offset:2048
    s_waitcnt vmcnt(18)
    v_mfma_f32_16x16x32_bf16 v[20:23], v[184:187], v[236:239], v[20:23]
    buffer_load_dwordx4 v[232:235], v2, s[36:39], s64 offen offset:0 sc1
    v_mfma_f32_16x16x32_bf16 v[36:39], v[188:191], v[236:239], v[36:39]
    ds_read_b64_tr_b16 v[176:177], v254 offset:0
    ds_read_b64_tr_b16 v[178:179], v254 offset:2048
    v_mfma_f32_16x16x32_bf16 v[52:55], v[192:195], v[236:239], v[52:55]
    ds_read_b64_tr_b16 v[180:181], v255 offset:0
    s_waitcnt lgkmcnt(14)
    ds_read_b64_tr_b16 v[182:183], v255 offset:2048
    v_mfma_f32_16x16x32_bf16 v[68:71], v[196:199], v[236:239], v[68:71]
    s_waitcnt vmcnt(15)
    v_mfma_f32_16x16x32_bf16 v[24:27], v[184:187], v[240:243], v[24:27]
    buffer_load_dwordx4 v[236:239], v2, s[36:39], s64 offen offset:1024 sc1
    v_mfma_f32_16x16x32_bf16 v[40:43], v[188:191], v[240:243], v[40:43]
    v_mfma_f32_16x16x32_bf16 v[56:59], v[192:195], v[240:243], v[56:59]
    v_mfma_f32_16x16x32_bf16 v[72:75], v[196:199], v[240:243], v[72:75]
    s_waitcnt vmcnt(14)
    v_mfma_f32_16x16x32_bf16 v[28:31], v[184:187], v[244:247], v[28:31]
    buffer_load_dwordx4 v[240:243], v2, s[36:39], s64 offen offset:2048 sc1
    v_mfma_f32_16x16x32_bf16 v[44:47], v[188:191], v[244:247], v[44:47]
    v_mfma_f32_16x16x32_bf16 v[60:63], v[192:195], v[244:247], v[60:63]
    v_mfma_f32_16x16x32_bf16 v[76:79], v[196:199], v[244:247], v[76:79]
    s_waitcnt lgkmcnt(8)
    s_waitcnt vmcnt(14)
    v_mfma_f32_16x16x32_bf16 v[16:19], v[152:155], v[200:203], v[16:19]
    buffer_load_dwordx4 v[244:247], v2, s[36:39], s64 offen offset:3072 sc1
    s_add_u32 s64, s64, s68
    v_mfma_f32_16x16x32_bf16 v[32:35], v[156:159], v[200:203], v[32:35]
    v_mfma_f32_16x16x32_bf16 v[48:51], v[160:163], v[200:203], v[48:51]
    ds_read_b64_tr_b16 v[184:185], v252 offset:16384
    ds_read_b64_tr_b16 v[186:187], v252 offset:18432
    v_mfma_f32_16x16x32_bf16 v[64:67], v[164:167], v[200:203], v[64:67]
    ds_read_b64_tr_b16 v[188:189], v253 offset:16384
    ds_read_b64_tr_b16 v[190:191], v253 offset:18432
    s_waitcnt vmcnt(14)
    v_mfma_f32_16x16x32_bf16 v[20:23], v[152:155], v[204:207], v[20:23]
    buffer_load_dwordx4 v[200:203], v2, s[36:39], s64 offen offset:0 sc1
    v_mfma_f32_16x16x32_bf16 v[36:39], v[156:159], v[204:207], v[36:39]
    ds_read_b64_tr_b16 v[192:193], v254 offset:16384
    ds_read_b64_tr_b16 v[194:195], v254 offset:18432
    v_mfma_f32_16x16x32_bf16 v[52:55], v[160:163], v[204:207], v[52:55]
    ds_read_b64_tr_b16 v[196:197], v255 offset:16384
    s_waitcnt lgkmcnt(14)
    ds_read_b64_tr_b16 v[198:199], v255 offset:18432
    v_mfma_f32_16x16x32_bf16 v[68:71], v[164:167], v[204:207], v[68:71]
    s_waitcnt vmcnt(11)
    v_mfma_f32_16x16x32_bf16 v[24:27], v[152:155], v[208:211], v[24:27]
    buffer_load_dwordx4 v[204:207], v2, s[36:39], s64 offen offset:1024 sc1
    v_mfma_f32_16x16x32_bf16 v[40:43], v[156:159], v[208:211], v[40:43]
    v_mfma_f32_16x16x32_bf16 v[56:59], v[160:163], v[208:211], v[56:59]
    v_mfma_f32_16x16x32_bf16 v[72:75], v[164:167], v[208:211], v[72:75]
    s_waitcnt vmcnt(10)
    v_mfma_f32_16x16x32_bf16 v[28:31], v[152:155], v[212:215], v[28:31]
    buffer_load_dwordx4 v[208:211], v2, s[36:39], s64 offen offset:2048 sc1
    v_mfma_f32_16x16x32_bf16 v[44:47], v[156:159], v[212:215], v[44:47]
    v_mfma_f32_16x16x32_bf16 v[60:63], v[160:163], v[212:215], v[60:63]
    v_mfma_f32_16x16x32_bf16 v[76:79], v[164:167], v[212:215], v[76:79]
    s_waitcnt lgkmcnt(8)
    s_waitcnt vmcnt(10)
    v_mfma_f32_16x16x32_bf16 v[16:19], v[168:171], v[216:219], v[16:19]
    buffer_load_dwordx4 v[212:215], v2, s[36:39], s64 offen offset:3072 sc1
    s_add_u32 s64, s64, s69
    v_mfma_f32_16x16x32_bf16 v[32:35], v[172:175], v[216:219], v[32:35]
    v_mfma_f32_16x16x32_bf16 v[48:51], v[176:179], v[216:219], v[48:51]
    ds_read_b64_tr_b16 v[152:153], v252 offset:32768
    ds_read_b64_tr_b16 v[154:155], v252 offset:34816
    v_mfma_f32_16x16x32_bf16 v[64:67], v[180:183], v[216:219], v[64:67]
    ds_read_b64_tr_b16 v[156:157], v253 offset:32768
    ds_read_b64_tr_b16 v[158:159], v253 offset:34816
    s_waitcnt vmcnt(10)
    v_mfma_f32_16x16x32_bf16 v[20:23], v[168:171], v[220:223], v[20:23]
    buffer_load_dwordx4 v[216:219], v2, s[36:39], s64 offen offset:0 sc1
    v_mfma_f32_16x16x32_bf16 v[36:39], v[172:175], v[220:223], v[36:39]
    ds_read_b64_tr_b16 v[160:161], v254 offset:32768
    ds_read_b64_tr_b16 v[162:163], v254 offset:34816
    v_mfma_f32_16x16x32_bf16 v[52:55], v[176:179], v[220:223], v[52:55]
    ds_read_b64_tr_b16 v[164:165], v255 offset:32768
    s_waitcnt lgkmcnt(14)
    ds_read_b64_tr_b16 v[166:167], v255 offset:34816
    v_mfma_f32_16x16x32_bf16 v[68:71], v[180:183], v[220:223], v[68:71]
    s_waitcnt vmcnt(10)
    v_mfma_f32_16x16x32_bf16 v[24:27], v[168:171], v[224:227], v[24:27]
    buffer_load_dwordx4 v[220:223], v2, s[36:39], s64 offen offset:1024 sc1
    v_mfma_f32_16x16x32_bf16 v[40:43], v[172:175], v[224:227], v[40:43]
    v_mfma_f32_16x16x32_bf16 v[56:59], v[176:179], v[224:227], v[56:59]
    v_mfma_f32_16x16x32_bf16 v[72:75], v[180:183], v[224:227], v[72:75]
    s_waitcnt vmcnt(10)
    v_mfma_f32_16x16x32_bf16 v[28:31], v[168:171], v[228:231], v[28:31]
    buffer_load_dwordx4 v[224:227], v2, s[36:39], s64 offen offset:2048 sc1
    v_mfma_f32_16x16x32_bf16 v[44:47], v[172:175], v[228:231], v[44:47]
    v_mfma_f32_16x16x32_bf16 v[60:63], v[176:179], v[228:231], v[60:63]
    v_mfma_f32_16x16x32_bf16 v[76:79], v[180:183], v[228:231], v[76:79]
    s_waitcnt lgkmcnt(8)
    s_waitcnt vmcnt(10)
    v_mfma_f32_16x16x32_bf16 v[16:19], v[184:187], v[232:235], v[16:19]
    buffer_load_dwordx4 v[228:231], v2, s[36:39], s64 offen offset:3072 sc1
    s_add_u32 s64, s64, s68
    v_mfma_f32_16x16x32_bf16 v[32:35], v[188:191], v[232:235], v[32:35]
    v_mfma_f32_16x16x32_bf16 v[48:51], v[192:195], v[232:235], v[48:51]
    ds_read_b64_tr_b16 v[168:169], v252 offset:49152
    ds_read_b64_tr_b16 v[170:171], v252 offset:51200
    v_mfma_f32_16x16x32_bf16 v[64:67], v[196:199], v[232:235], v[64:67]
    ds_read_b64_tr_b16 v[172:173], v253 offset:49152
    ds_read_b64_tr_b16 v[174:175], v253 offset:51200
    s_waitcnt vmcnt(10)
    v_mfma_f32_16x16x32_bf16 v[20:23], v[184:187], v[236:239], v[20:23]
    buffer_load_dwordx4 v[232:235], v2, s[36:39], s64 offen offset:0 sc1
    v_mfma_f32_16x16x32_bf16 v[36:39], v[188:191], v[236:239], v[36:39]
    ds_read_b64_tr_b16 v[176:177], v254 offset:49152
    ds_read_b64_tr_b16 v[178:179], v254 offset:51200
    v_mfma_f32_16x16x32_bf16 v[52:55], v[192:195], v[236:239], v[52:55]
    ds_read_b64_tr_b16 v[180:181], v255 offset:49152
    s_waitcnt lgkmcnt(14)
    ds_read_b64_tr_b16 v[182:183], v255 offset:51200
    v_mfma_f32_16x16x32_bf16 v[68:71], v[196:199], v[236:239], v[68:71]
    s_waitcnt vmcnt(10)
    v_mfma_f32_16x16x32_bf16 v[24:27], v[184:187], v[240:243], v[24:27]
    buffer_load_dwordx4 v[236:239], v2, s[36:39], s64 offen offset:1024 sc1
    v_mfma_f32_16x16x32_bf16 v[40:43], v[188:191], v[240:243], v[40:43]
    v_mfma_f32_16x16x32_bf16 v[56:59], v[192:195], v[240:243], v[56:59]
    v_mfma_f32_16x16x32_bf16 v[72:75], v[196:199], v[240:243], v[72:75]
    s_waitcnt vmcnt(10)
    v_mfma_f32_16x16x32_bf16 v[28:31], v[184:187], v[244:247], v[28:31]
    buffer_load_dwordx4 v[240:243], v2, s[36:39], s64 offen offset:2048 sc1
    v_mfma_f32_16x16x32_bf16 v[44:47], v[188:191], v[244:247], v[44:47]
    v_mfma_f32_16x16x32_bf16 v[60:63], v[192:195], v[244:247], v[60:63]
    v_mfma_f32_16x16x32_bf16 v[76:79], v[196:199], v[244:247], v[76:79]
    s_waitcnt lgkmcnt(8)
    s_waitcnt vmcnt(10)
    v_mfma_f32_16x16x32_bf16 v[16:19], v[152:155], v[200:203], v[16:19]
    buffer_load_dwordx4 v[244:247], v2, s[36:39], s64 offen offset:3072 sc1
    s_add_u32 s64, s64, s69
    v_mfma_f32_16x16x32_bf16 v[32:35], v[156:159], v[200:203], v[32:35]
    v_mfma_f32_16x16x32_bf16 v[48:51], v[160:163], v[200:203], v[48:51]
    ds_read_b64_tr_b16 v[184:185], v248 offset:32768
    ds_read_b64_tr_b16 v[186:187], v248 offset:34816
    v_mfma_f32_16x16x32_bf16 v[64:67], v[164:167], v[200:203], v[64:67]
    ds_read_b64_tr_b16 v[188:189], v249 offset:32768
    ds_read_b64_tr_b16 v[190:191], v249 offset:34816
    s_waitcnt vmcnt(10)
    v_mfma_f32_16x16x32_bf16 v[20:23], v[152:155], v[204:207], v[20:23]
    buffer_load_dwordx4 v[200:203], v2, s[36:39], s64 offen offset:0 sc1
    v_mfma_f32_16x16x32_bf16 v[36:39], v[156:159], v[204:207], v[36:39]
    ds_read_b64_tr_b16 v[192:193], v250 offset:32768
    ds_read_b64_tr_b16 v[194:195], v250 offset:34816
    v_mfma_f32_16x16x32_bf16 v[52:55], v[160:163], v[204:207], v[52:55]
    ds_read_b64_tr_b16 v[196:197], v251 offset:32768
    s_waitcnt lgkmcnt(14)
    ds_read_b64_tr_b16 v[198:199], v251 offset:34816
    v_mfma_f32_16x16x32_bf16 v[68:71], v[164:167], v[204:207], v[68:71]
    s_waitcnt vmcnt(10)
    v_mfma_f32_16x16x32_bf16 v[24:27], v[152:155], v[208:211], v[24:27]
    buffer_load_dwordx4 v[204:207], v2, s[36:39], s64 offen offset:1024 sc1
    v_mfma_f32_16x16x32_bf16 v[40:43], v[156:159], v[208:211], v[40:43]
    v_mfma_f32_16x16x32_bf16 v[56:59], v[160:163], v[208:211], v[56:59]
    v_mfma_f32_16x16x32_bf16 v[72:75], v[164:167], v[208:211], v[72:75]
    s_waitcnt vmcnt(10)
    v_mfma_f32_16x16x32_bf16 v[28:31], v[152:155], v[212:215], v[28:31]
    buffer_load_dwordx4 v[208:211], v2, s[36:39], s64 offen offset:2048 sc1
    v_mfma_f32_16x16x32_bf16 v[44:47], v[156:159], v[212:215], v[44:47]
    v_mfma_f32_16x16x32_bf16 v[60:63], v[160:163], v[212:215], v[60:63]
    v_mfma_f32_16x16x32_bf16 v[76:79], v[164:167], v[212:215], v[76:79]
    s_waitcnt lgkmcnt(8)
    s_waitcnt vmcnt(10)
    v_mfma_f32_16x16x32_bf16 v[16:19], v[168:171], v[216:219], v[16:19]
    buffer_load_dwordx4 v[212:215], v2, s[36:39], s64 offen offset:3072 sc1
    s_add_u32 s64, s64, s68
    v_mfma_f32_16x16x32_bf16 v[32:35], v[172:175], v[216:219], v[32:35]
    v_mfma_f32_16x16x32_bf16 v[48:51], v[176:179], v[216:219], v[48:51]
    ds_read_b64_tr_b16 v[152:153], v248 offset:0
    ds_read_b64_tr_b16 v[154:155], v248 offset:2048
    v_mfma_f32_16x16x32_bf16 v[64:67], v[180:183], v[216:219], v[64:67]
    ds_read_b64_tr_b16 v[156:157], v249 offset:0
    ds_read_b64_tr_b16 v[158:159], v249 offset:2048
    s_waitcnt vmcnt(10)
    v_mfma_f32_16x16x32_bf16 v[20:23], v[168:171], v[220:223], v[20:23]
    buffer_load_dwordx4 v[216:219], v2, s[36:39], s64 offen offset:0 sc1
    v_mfma_f32_16x16x32_bf16 v[36:39], v[172:175], v[220:223], v[36:39]
    ds_read_b64_tr_b16 v[160:161], v250 offset:0
    ds_read_b64_tr_b16 v[162:163], v250 offset:2048
    v_mfma_f32_16x16x32_bf16 v[52:55], v[176:179], v[220:223], v[52:55]
    ds_read_b64_tr_b16 v[164:165], v251 offset:0
    s_waitcnt lgkmcnt(14)
    ds_read_b64_tr_b16 v[166:167], v251 offset:2048
    v_mfma_f32_16x16x32_bf16 v[68:71], v[180:183], v[220:223], v[68:71]
    s_waitcnt vmcnt(10)
    v_mfma_f32_16x16x32_bf16 v[24:27], v[168:171], v[224:227], v[24:27]
    buffer_load_dwordx4 v[220:223], v2, s[36:39], s64 offen offset:1024 sc1
    v_mfma_f32_16x16x32_bf16 v[40:43], v[172:175], v[224:227], v[40:43]
    v_mfma_f32_16x16x32_bf16 v[56:59], v[176:179], v[224:227], v[56:59]
    v_mfma_f32_16x16x32_bf16 v[72:75], v[180:183], v[224:227], v[72:75]
    s_waitcnt vmcnt(10)
    v_mfma_f32_16x16x32_bf16 v[28:31], v[168:171], v[228:231], v[28:31]
    buffer_load_dwordx4 v[224:227], v2, s[36:39], s64 offen offset:2048 sc1
    v_mfma_f32_16x16x32_bf16 v[44:47], v[172:175], v[228:231], v[44:47]
    v_mfma_f32_16x16x32_bf16 v[60:63], v[176:179], v[228:231], v[60:63]
    v_mfma_f32_16x16x32_bf16 v[76:79], v[180:183], v[228:231], v[76:79]
    s_waitcnt lgkmcnt(8)
    s_waitcnt vmcnt(10)
    v_mfma_f32_16x16x32_bf16 v[16:19], v[184:187], v[232:235], v[16:19]
    buffer_load_dwordx4 v[228:231], v2, s[36:39], s64 offen offset:3072 sc1
    s_add_u32 s64, s64, s69
    v_mfma_f32_16x16x32_bf16 v[32:35], v[188:191], v[232:235], v[32:35]
    v_mfma_f32_16x16x32_bf16 v[48:51], v[192:195], v[232:235], v[48:51]
    ds_read_b64_tr_b16 v[168:169], v248 offset:49152
    ds_read_b64_tr_b16 v[170:171], v248 offset:51200
    v_mfma_f32_16x16x32_bf16 v[64:67], v[196:199], v[232:235], v[64:67]
    ds_read_b64_tr_b16 v[172:173], v249 offset:49152
    ds_read_b64_tr_b16 v[174:175], v249 offset:51200
    s_waitcnt vmcnt(10)
    v_mfma_f32_16x16x32_bf16 v[20:23], v[184:187], v[236:239], v[20:23]
    v_mov_b32 v144, 163792
PK_BSY:
    ds_read_b32 v145, v144
    s_waitcnt lgkmcnt(0)
    v_readfirstlane_b32 s11, v145
    s_nop 0
    s_cmp_lt_u32 s11, 4
    s_cbranch_scc1 PK_BSY
    buffer_load_dwordx4 v[144:147], v11, s[36:39], s62 offen sc1
    s_add_u32 s10, s65, 131072
    buffer_load_dwordx4 v[232:235], v8, s[36:39], s10 offen sc1
    v_mfma_f32_16x16x32_bf16 v[36:39], v[188:191], v[236:239], v[36:39]
    ds_read_b64_tr_b16 v[176:177], v250 offset:49152
    ds_read_b64_tr_b16 v[178:179], v250 offset:51200
    v_mfma_f32_16x16x32_bf16 v[52:55], v[192:195], v[236:239], v[52:55]
    ds_read_b64_tr_b16 v[180:181], v251 offset:49152
    ds_read_b64_tr_b16 v[182:183], v251 offset:51200
    v_mfma_f32_16x16x32_bf16 v[68:71], v[196:199], v[236:239], v[68:71]
    s_waitcnt vmcnt(11)
    v_mfma_f32_16x16x32_bf16 v[24:27], v[184:187], v[240:243], v[24:27]
    s_add_u32 s10, s65, 139264
    buffer_load_dwordx4 v[236:239], v8, s[36:39], s10 offen sc1
    v_mfma_f32_16x16x32_bf16 v[40:43], v[188:191], v[240:243], v[40:43]
    v_mfma_f32_16x16x32_bf16 v[56:59], v[192:195], v[240:243], v[56:59]
    v_mfma_f32_16x16x32_bf16 v[72:75], v[196:199], v[240:243], v[72:75]
    s_waitcnt vmcnt(11)
    v_mfma_f32_16x16x32_bf16 v[28:31], v[184:187], v[244:247], v[28:31]
    s_add_u32 s10, s65, 147456
    buffer_load_dwordx4 v[240:243], v8, s[36:39], s10 offen sc1
    v_mfma_f32_16x16x32_bf16 v[44:47], v[188:191], v[244:247], v[44:47]
    v_mfma_f32_16x16x32_bf16 v[60:63], v[192:195], v[244:247], v[60:63]
    v_mfma_f32_16x16x32_bf16 v[76:79], v[196:199], v[244:247], v[76:79]
    s_waitcnt vmcnt(11)
    v_mfma_f32_16x16x32_bf16 v[16:19], v[152:155], v[200:203], v[16:19]
    s_add_u32 s10, s65, 155648
    buffer_load_dwordx4 v[244:247], v8, s[36:39], s10 offen sc1
    v_mfma_f32_16x16x32_bf16 v[32:35], v[156:159], v[200:203], v[32:35]
    s_add_u32 s10, s65, 262144
    buffer_load_dwordx4 v[184:187], v8, s[36:39], s10 offen sc1
    v_mfma_f32_16x16x32_bf16 v[48:51], v[160:163], v[200:203], v[48:51]
    s_add_u32 s10, s65, 270336
    buffer_load_dwordx4 v[188:191], v8, s[36:39], s10 offen sc1
    v_mfma_f32_16x16x32_bf16 v[64:67], v[164:167], v[200:203], v[64:67]
    s_add_u32 s10, s65, 278528
    buffer_load_dwordx4 v[192:195], v8, s[36:39], s10 offen sc1
    s_waitcnt vmcnt(14)
    v_mfma_f32_16x16x32_bf16 v[20:23], v[152:155], v[204:207], v[20:23]
    s_add_u32 s10, s65, 393216
    buffer_load_dwordx4 v[200:203], v8, s[36:39], s10 offen sc1
    v_mfma_f32_16x16x32_bf16 v[36:39], v[156:159], v[204:207], v[36:39]
    s_add_u32 s10, s65, 286720
    buffer_load_dwordx4 v[196:199], v8, s[36:39], s10 offen sc1
    v_mfma_f32_16x16x32_bf16 v[52:55], v[160:163], v[204:207], v[52:55]
    v_mfma_f32_16x16x32_bf16 v[68:71], v[164:167], v[204:207], v[68:71]
    s_waitcnt vmcnt(15)
    v_mfma_f32_16x16x32_bf16 v[24:27], v[152:155], v[208:211], v[24:27]
    s_add_u32 s10, s65, 401408
    buffer_load_dwordx4 v[204:207], v8, s[36:39], s10 offen sc1
    v_mfma_f32_16x16x32_bf16 v[40:43], v[156:159], v[208:211], v[40:43]
    v_mfma_f32_16x16x32_bf16 v[56:59], v[160:163], v[208:211], v[56:59]
    v_mfma_f32_16x16x32_bf16 v[72:75], v[164:167], v[208:211], v[72:75]
    s_waitcnt vmcnt(15)
    v_mfma_f32_16x16x32_bf16 v[28:31], v[152:155], v[212:215], v[28:31]
    s_add_u32 s10, s65, 409600
    buffer_load_dwordx4 v[208:211], v8, s[36:39], s10 offen sc1
    v_mfma_f32_16x16x32_bf16 v[44:47], v[156:159], v[212:215], v[44:47]
    v_mfma_f32_16x16x32_bf16 v[60:63], v[160:163], v[212:215], v[60:63]
    v_mfma_f32_16x16x32_bf16 v[76:79], v[164:167], v[212:215], v[76:79]
    s_waitcnt lgkmcnt(0)
    s_waitcnt vmcnt(15)
    v_mfma_f32_16x16x32_bf16 v[16:19], v[168:171], v[216:219], v[16:19]
    s_add_u32 s10, s65, 417792
    buffer_load_dwordx4 v[212:215], v8, s[36:39], s10 offen sc1
    v_mfma_f32_16x16x32_bf16 v[32:35], v[172:175], v[216:219], v[32:35]
    s_add_u32 s10, s65, 0
    buffer_load_dwordx4 v[152:155], v8, s[36:39], s10 offen sc1
    v_mfma_f32_16x16x32_bf16 v[48:51], v[176:179], v[216:219], v[48:51]
    s_add_u32 s10, s65, 8192
    buffer_load_dwordx4 v[156:159], v8, s[36:39], s10 offen sc1
    v_mfma_f32_16x16x32_bf16 v[64:67], v[180:183], v[216:219], v[64:67]
    s_add_u32 s10, s65, 16384
    buffer_load_dwordx4 v[160:163], v8, s[36:39], s10 offen sc1
    s_waitcnt vmcnt(18)
    v_mfma_f32_16x16x32_bf16 v[20:23], v[168:171], v[220:223], v[20:23]
    v_mfma_f32_16x16x32_bf16 v[36:39], v[172:175], v[220:223], v[36:39]
    s_add_u32 s10, s65, 24576
    buffer_load_dwordx4 v[164:167], v8, s[36:39], s10 offen sc1
    v_mfma_f32_16x16x32_bf16 v[52:55], v[176:179], v[220:223], v[52:55]
    s_waitcnt vmcnt(16)
    v_sub_f32 v151, 1.0, v147
    v_sub_f32 v150, 1.0, v147
    v_sub_f32 v149, 1.0, v146
    v_sub_f32 v148, 1.0, v146
    v_sub_f32 v147, 1.0, v145
    v_sub_f32 v146, 1.0, v145
    v_sub_f32 v145, 1.0, v144
    v_sub_f32 v144, 1.0, v144
    v_mfma_f32_16x16x32_bf16 v[68:71], v[180:183], v[220:223], v[68:71]
    s_waitcnt vmcnt(12)
    v_and_b32 v3, v232, v236
    v_and_b32 v10, v240, v244
    v_mfma_f32_16x16x32_bf16 v[24:27], v[168:171], v[224:227], v[24:27]
    v_mfma_f32_16x16x32_bf16 v[40:43], v[172:175], v[224:227], v[40:43]
    v_and_b32 v3, v3, v10
    v_and_b32 v3, 1, v3
    v_mfma_f32_16x16x32_bf16 v[56:59], v[176:179], v[224:227], v[56:59]
    v_cmp_eq_u32 vcc, 0, v3
    v_mfma_f32_16x16x32_bf16 v[72:75], v[180:183], v[224:227], v[72:75]
    s_cbranch_vccnz PK_ZS0
PK_ZG0:
    v_mfma_f32_16x16x32_bf16 v[28:31], v[168:171], v[228:231], v[28:31]
    v_mfma_f32_16x16x32_bf16 v[44:47], v[172:175], v[228:231], v[44:47]
    v_swap_b32 v233, v236
    v_swap_b32 v234, v240
    v_mfma_f32_16x16x32_bf16 v[60:63], v[176:179], v[228:231], v[60:63]
    v_swap_b32 v235, v244
    v_swap_b32 v238, v241
    v_mfma_f32_16x16x32_bf16 v[76:79], v[180:183], v[228:231], v[76:79]
    v_swap_b32 v239, v245
    v_swap_b32 v243, v246
    v_pk_mul_f32 v[16:17], v[16:17], v[144:145]
    v_pk_mul_f32 v[18:19], v[18:19], v[144:145]
    v_pk_mul_f32 v[32:33], v[32:33], v[144:145]
    v_pk_mul_f32 v[34:35], v[34:35], v[144:145]
    v_pk_mul_f32 v[48:49], v[48:49], v[144:145]
    v_pk_mul_f32 v[50:51], v[50:51], v[144:145]
    v_pk_mul_f32 v[64:65], v[64:65], v[144:145]
    v_pk_mul_f32 v[66:67], v[66:67], v[144:145]
    v_pk_mul_f32 v[20:21], v[20:21], v[146:147]
    v_pk_mul_f32 v[22:23], v[22:23], v[146:147]
    v_pk_mul_f32 v[36:37], v[36:37], v[146:147]
    v_pk_mul_f32 v[38:39], v[38:39], v[146:147]
    v_pk_mul_f32 v[52:53], v[52:53], v[146:147]
    v_pk_mul_f32 v[54:55], v[54:55], v[146:147]
    v_pk_mul_f32 v[68:69], v[68:69], v[146:147]
    v_pk_mul_f32 v[70:71], v[70:71], v[146:147]
    v_pk_mul_f32 v[24:25], v[24:25], v[148:149]
    v_pk_mul_f32 v[26:27], v[26:27], v[148:149]
    v_pk_mul_f32 v[40:41], v[40:41], v[148:149]
    v_pk_mul_f32 v[42:43], v[42:43], v[148:149]
    v_pk_mul_f32 v[56:57], v[56:57], v[148:149]
    v_pk_mul_f32 v[58:59], v[58:59], v[148:149]
    v_pk_mul_f32 v[72:73], v[72:73], v[148:149]
    v_pk_mul_f32 v[74:75], v[74:75], v[148:149]
    v_pk_mul_f32 v[28:29], v[28:29], v[150:151]
    v_pk_mul_f32 v[30:31], v[30:31], v[150:151]
    v_pk_mul_f32 v[44:45], v[44:45], v[150:151]
    v_pk_mul_f32 v[46:47], v[46:47], v[150:151]
    v_pk_mul_f32 v[60:61], v[60:61], v[150:151]
    v_pk_mul_f32 v[62:63], v[62:63], v[150:151]
    v_pk_mul_f32 v[76:77], v[76:77], v[150:151]
    v_pk_mul_f32 v[78:79], v[78:79], v[150:151]
    v_mfma_f32_16x16x32_bf16 v[16:19], v[96:99], v[232:235], v[16:19]
    s_waitcnt vmcnt(7)
    v_and_b32 v3, v184, v188
    v_and_b32 v10, v192, v196
    v_mfma_f32_16x16x32_bf16 v[32:35], v[100:103], v[232:235], v[32:35]
    v_and_b32 v3, v3, v10
    v_and_b32 v3, 1, v3
    v_mfma_f32_16x16x32_bf16 v[48:51], v[104:107], v[232:235], v[48:51]
    v_cmp_eq_u32 vcc, 0, v3
    v_mfma_f32_16x16x32_bf16 v[64:67], v[108:111], v[232:235], v[64:67]
    s_cbranch_vccnz PK_ZS1
PK_ZG1:
    v_mfma_f32_16x16x32_bf16 v[20:23], v[96:99], v[236:239], v[20:23]
    v_swap_b32 v185, v188
    v_swap_b32 v186, v192
    v_mfma_f32_16x16x32_bf16 v[36:39], v[100:103], v[236:239], v[36:39]
    v_swap_b32 v187, v196
    v_swap_b32 v190, v193
    v_mfma_f32_16x16x32_bf16 v[52:55], v[104:107], v[236:239], v[52:55]
    v_swap_b32 v191, v197
    v_swap_b32 v195, v198
    v_mfma_f32_16x16x32_bf16 v[68:71], v[108:111], v[236:239], v[68:71]
    s_waitcnt vmcnt(4)
    v_and_b32 v3, v200, v204
    v_and_b32 v10, v208, v212
    v_mfma_f32_16x16x32_bf16 v[24:27], v[96:99], v[240:243], v[24:27]
    v_and_b32 v3, v3, v10
    v_and_b32 v3, 1, v3
    v_mfma_f32_16x16x32_bf16 v[40:43], v[100:103], v[240:243], v[40:43]
    v_cmp_eq_u32 vcc, 0, v3
    v_mfma_f32_16x16x32_bf16 v[56:59], v[104:107], v[240:243], v[56:59]
    s_cbranch_vccnz PK_ZS2
PK_ZG2:
    v_mfma_f32_16x16x32_bf16 v[72:75], v[108:111], v[240:243], v[72:75]
    v_swap_b32 v201, v204
    v_swap_b32 v202, v208
    v_mfma_f32_16x16x32_bf16 v[28:31], v[96:99], v[244:247], v[28:31]
    v_swap_b32 v203, v212
    v_swap_b32 v206, v209
    v_mfma_f32_16x16x32_bf16 v[44:47], v[100:103], v[244:247], v[44:47]
    v_swap_b32 v207, v213
    v_swap_b32 v211, v214
    v_mfma_f32_16x16x32_bf16 v[60:63], v[104:107], v[244:247], v[60:63]
    s_waitcnt vmcnt(0)
    v_and_b32 v3, v152, v156
    v_and_b32 v10, v160, v164
    v_mfma_f32_16x16x32_bf16 v[76:79], v[108:111], v[244:247], v[76:79]
    v_and_b32 v3, v3, v10
    v_and_b32 v3, 1, v3
    v_mfma_f32_16x16x32_bf16 v[16:19], v[112:115], v[184:187], v[16:19]
    v_cmp_eq_u32 vcc, 0, v3
    v_mfma_f32_16x16x32_bf16 v[20:23], v[112:115], v[188:191], v[20:23]
    s_cbranch_vccnz PK_ZS3
PK_ZG3:
    v_mfma_f32_16x16x32_bf16 v[24:27], v[112:115], v[192:195], v[24:27]
    v_swap_b32 v153, v156
    v_swap_b32 v154, v160
    v_mfma_f32_16x16x32_bf16 v[28:31], v[112:115], v[196:199], v[28:31]
    v_swap_b32 v155, v164
    v_swap_b32 v158, v161
    v_mfma_f32_16x16x32_bf16 v[16:19], v[128:131], v[200:203], v[16:19]
    v_swap_b32 v159, v165
    v_swap_b32 v163, v166
    v_mfma_f32_16x16x32_bf16 v[20:23], v[128:131], v[204:207], v[20:23]
    v_mfma_f32_16x16x32_bf16 v[24:27], v[128:131], v[208:211], v[24:27]
    v_mfma_f32_16x16x32_bf16 v[28:31], v[128:131], v[212:215], v[28:31]
    v_mfma_f32_16x16x32_bf16 v[16:19], v[80:83], v[152:155], v[16:19]
    v_mfma_f32_16x16x32_bf16 v[20:23], v[80:83], v[156:159], v[20:23]
    v_mfma_f32_16x16x32_bf16 v[24:27], v[80:83], v[160:163], v[24:27]
    v_mfma_f32_16x16x32_bf16 v[28:31], v[80:83], v[164:167], v[28:31]
    v_mfma_f32_16x16x32_bf16 v[32:35], v[116:119], v[184:187], v[32:35]
    v_mfma_f32_16x16x32_bf16 v[36:39], v[116:119], v[188:191], v[36:39]
    v_mfma_f32_16x16x32_bf16 v[40:43], v[116:119], v[192:195], v[40:43]
    v_mfma_f32_16x16x32_bf16 v[44:47], v[116:119], v[196:199], v[44:47]
    v_mfma_f32_16x16x32_bf16 v[32:35], v[132:135], v[200:203], v[32:35]
    ds_write_b128 v4, v[16:19] offset:0
    v_mfma_f32_16x16x32_bf16 v[36:39], v[132:135], v[204:207], v[36:39]
    v_mfma_f32_16x16x32_bf16 v[40:43], v[132:135], v[208:211], v[40:43]
    ds_write_b128 v4, v[20:23] offset:1024
    v_mfma_f32_16x16x32_bf16 v[44:47], v[132:135], v[212:215], v[44:47]
    v_mfma_f32_16x16x32_bf16 v[32:35], v[84:87], v[152:155], v[32:35]
    ds_write_b128 v4, v[24:27] offset:2048
    v_mfma_f32_16x16x32_bf16 v[36:39], v[84:87], v[156:159], v[36:39]
    v_mfma_f32_16x16x32_bf16 v[40:43], v[84:87], v[160:163], v[40:43]
    ds_write_b128 v4, v[28:31] offset:3072
    v_mfma_f32_16x16x32_bf16 v[44:47], v[84:87], v[164:167], v[44:47]
    v_mfma_f32_16x16x32_bf16 v[48:51], v[120:123], v[184:187], v[48:51]
    v_mfma_f32_16x16x32_bf16 v[52:55], v[120:123], v[188:191], v[52:55]
    v_mfma_f32_16x16x32_bf16 v[56:59], v[120:123], v[192:195], v[56:59]
    v_mfma_f32_16x16x32_bf16 v[60:63], v[120:123], v[196:199], v[60:63]
    v_mfma_f32_16x16x32_bf16 v[48:51], v[136:139], v[200:203], v[48:51]
    ds_write_b128 v5, v[32:35] offset:0
    v_mfma_f32_16x16x32_bf16 v[52:55], v[136:139], v[204:207], v[52:55]
    v_mfma_f32_16x16x32_bf16 v[56:59], v[136:139], v[208:211], v[56:59]
    ds_write_b128 v5, v[36:39] offset:1024
    v_mfma_f32_16x16x32_bf16 v[60:63], v[136:139], v[212:215], v[60:63]
    v_mfma_f32_16x16x32_bf16 v[48:51], v[88:91], v[152:155], v[48:51]
    ds_write_b128 v5, v[40:43] offset:2048
    v_mfma_f32_16x16x32_bf16 v[52:55], v[88:91], v[156:159], v[52:55]
    v_mfma_f32_16x16x32_bf16 v[56:59], v[88:91], v[160:163], v[56:59]
    ds_write_b128 v5, v[44:47] offset:3072
    v_mfma_f32_16x16x32_bf16 v[60:63], v[88:91], v[164:167], v[60:63]
    v_mfma_f32_16x16x32_bf16 v[64:67], v[124:127], v[184:187], v[64:67]
    v_mfma_f32_16x16x32_bf16 v[68:71], v[124:127], v[188:191], v[68:71]
    v_mfma_f32_16x16x32_bf16 v[72:75], v[124:127], v[192:195], v[72:75]
    v_mfma_f32_16x16x32_bf16 v[76:79], v[124:127], v[196:199], v[76:79]
    v_mfma_f32_16x16x32_bf16 v[64:67], v[140:143], v[200:203], v[64:67]
    ds_write_b128 v6, v[48:51] offset:0
    v_mfma_f32_16x16x32_bf16 v[68:71], v[140:143], v[204:207], v[68:71]
    v_mfma_f32_16x16x32_bf16 v[72:75], v[140:143], v[208:211], v[72:75]
    ds_write_b128 v6, v[52:55] offset:1024
    v_mfma_f32_16x16x32_bf16 v[76:79], v[140:143], v[212:215], v[76:79]
    v_mfma_f32_16x16x32_bf16 v[64:67], v[92:95], v[152:155], v[64:67]
    ds_write_b128 v6, v[56:59] offset:2048
    v_mfma_f32_16x16x32_bf16 v[68:71], v[92:95], v[156:159], v[68:71]
    v_mfma_f32_16x16x32_bf16 v[72:75], v[92:95], v[160:163], v[72:75]
    ds_write_b128 v6, v[60:63] offset:3072
    v_mfma_f32_16x16x32_bf16 v[76:79], v[92:95], v[164:167], v[76:79]
    s_nop 2
    ds_write_b128 v7, v[64:67] offset:0
    s_nop 0
    ds_write_b128 v7, v[68:71] offset:1024
    ds_write_b128 v7, v[72:75] offset:2048
    s_waitcnt lgkmcnt(14)
    ds_write_b128 v7, v[76:79] offset:3072
PK_FIN:
    v_lshrrev_b32 v80, 3, v1
    s_and_b32 s10, s58, 1
    s_lshl_b32 s10, s10, 3
    v_add_u32 v80, s10, v80
    v_and_b32 v81, 7, v1
    v_lshlrev_b32 v82, 1, v81
    v_xor_b32 v82, v82, v80
    v_lshlrev_b32 v82, 4, v82
    v_and_b32 v83, 1, v1
    v_lshl_add_u32 v82, v83, 9, v82
    v_bfe_u32 v83, v1, 1, 2
    v_lshl_add_u32 v82, v83, 14, v82
    s_lshr_b32 s3, s58, 1
    s_lshl_b32 s10, s3, 10
    v_add_u32 v10, s10, v82
    v_lshlrev_b32 v80, 10, v80
    v_lshl_add_u32 v9, v81, 4, v80
    s_lshr_b32 s11, s78, 4
    s_lshl_b32 s10, s11, 14
    s_and_b32 s11, s78, 15
    s_lshl_b32 s11, s11, 17
    s_add_u32 s10, s10, s11
    s_lshl_b32 s11, s3, 15
    s_add_u32 s10, s10, s11
    s_lshl_b32 s11, s79, 7
    s_add_u32 s63, s10, s11
    s_mov_b32 s28, s20
    s_mov_b32 s29, s21
    s_mov_b32 s30, 2097152
    s_mov_b32 s31, 0x20000
    s_waitcnt lgkmcnt(0)
    s_barrier
    ds_read_b128 v[80:83], v10 offset:0
    ds_read_b128 v[84:87], v10 offset:256
    ds_read_b128 v[88:91], v10 offset:4096
    ds_read_b128 v[92:95], v10 offset:4352
    ds_read_b128 v[96:99], v10 offset:8192
    ds_read_b128 v[100:103], v10 offset:8448
    ds_read_b128 v[104:107], v10 offset:12288
    ds_read_b128 v[108:111], v10 offset:12544
    s_waitcnt lgkmcnt(4)
    v_pk_add_f32 v[80:81], v[80:81], v[88:89]
    v_pk_add_f32 v[82:83], v[82:83], v[90:91]
    v_pk_add_f32 v[84:85], v[84:85], v[92:93]
    v_pk_add_f32 v[86:87], v[86:87], v[94:95]
    s_waitcnt lgkmcnt(0)
    v_pk_add_f32 v[96:97], v[96:97], v[104:105]
    v_pk_add_f32 v[98:99], v[98:99], v[106:107]
    v_pk_add_f32 v[100:101], v[100:101], v[108:109]
    v_pk_add_f32 v[102:103], v[102:103], v[110:111]
    v_pk_add_f32 v[80:81], v[80:81], v[96:97]
    v_pk_add_f32 v[82:83], v[82:83], v[98:99]
    v_pk_add_f32 v[84:85], v[84:85], v[100:101]
    v_pk_add_f32 v[86:87], v[86:87], v[102:103]
    v_cvt_pk_bf16_f32 v88, v80, v81
    v_cvt_pk_bf16_f32 v89, v82, v83
    v_cvt_pk_bf16_f32 v90, v84, v85
    v_cvt_pk_bf16_f32 v91, v86, v87
    buffer_store_dwordx4 v[88:91], v9, s[28:31], s63 offen sc1
    s_or_b32 s10, s2, s58
    s_cbranch_scc1 PK_NOEP
    s_mov_b32 s10, 15593472
    v_mov_b32 v4, s22
    s_mov_b64 exec, 1
    buffer_store_dword v4, v15, s[36:39], s10 offen sc1
    s_mov_b64 exec, -1
PK_NOEP:
    s_endpgm
PK_ZS0:
    s_sub_u32 s67, s67, 1
    s_cbranch_scc1 PK_ZX0
    s_mov_b64 exec, vcc
    s_sleep 4
    s_add_u32 s10, s65, 131072
    buffer_load_dwordx4 v[232:235], v8, s[36:39], s10 offen sc1
    s_add_u32 s10, s65, 139264
    buffer_load_dwordx4 v[236:239], v8, s[36:39], s10 offen sc1
    s_add_u32 s10, s65, 147456
    buffer_load_dwordx4 v[240:243], v8, s[36:39], s10 offen sc1
    s_add_u32 s10, s65, 155648
    buffer_load_dwordx4 v[244:247], v8, s[36:39], s10 offen sc1
    s_waitcnt vmcnt(0)
    v_and_b32 v3, v232, v236
    v_and_b32 v10, v240, v244
    v_and_b32 v3, v3, v10
    v_and_b32 v3, 1, v3
    v_cmp_eq_u32 vcc, 0, v3
    s_cbranch_vccnz PK_ZS0
PK_ZX0:
    s_mov_b64 exec, -1
    s_branch PK_ZG0
PK_ZS1:
    s_sub_u32 s67, s67, 1
    s_cbranch_scc1 PK_ZX1
    s_mov_b64 exec, vcc
    s_sleep 4
    s_add_u32 s10, s65, 262144
    buffer_load_dwordx4 v[184:187], v8, s[36:39], s10 offen sc1
    s_add_u32 s10, s65, 270336
    buffer_load_dwordx4 v[188:191], v8, s[36:39], s10 offen sc1
    s_add_u32 s10, s65, 278528
    buffer_load_dwordx4 v[192:195], v8, s[36:39], s10 offen sc1
    s_add_u32 s10, s65, 286720
    buffer_load_dwordx4 v[196:199], v8, s[36:39], s10 offen sc1
    s_waitcnt vmcnt(0)
    v_and_b32 v3, v184, v188
    v_and_b32 v10, v192, v196
    v_and_b32 v3, v3, v10
    v_and_b32 v3, 1, v3
    v_cmp_eq_u32 vcc, 0, v3
    s_cbranch_vccnz PK_ZS1
PK_ZX1:
    s_mov_b64 exec, -1
    s_branch PK_ZG1
PK_ZS2:
    s_sub_u32 s67, s67, 1
    s_cbranch_scc1 PK_ZX2
    s_mov_b64 exec, vcc
    s_sleep 4
    s_add_u32 s10, s65, 393216
    buffer_load_dwordx4 v[200:203], v8, s[36:39], s10 offen sc1
    s_add_u32 s10, s65, 401408
    buffer_load_dwordx4 v[204:207], v8, s[36:39], s10 offen sc1
    s_add_u32 s10, s65, 409600
    buffer_load_dwordx4 v[208:211], v8, s[36:39], s10 offen sc1
    s_add_u32 s10, s65, 417792
    buffer_load_dwordx4 v[212:215], v8, s[36:39], s10 offen sc1
    s_waitcnt vmcnt(0)
    v_and_b32 v3, v200, v204
    v_and_b32 v10, v208, v212
    v_and_b32 v3, v3, v10
    v_and_b32 v3, 1, v3
    v_cmp_eq_u32 vcc, 0, v3
    s_cbranch_vccnz PK_ZS2
PK_ZX2:
    s_mov_b64 exec, -1
    s_branch PK_ZG2
PK_ZS3:
    s_sub_u32 s67, s67, 1
    s_cbranch_scc1 PK_ZX3
    s_mov_b64 exec, vcc
    s_sleep 4
    s_add_u32 s10, s65, 0
    buffer_load_dwordx4 v[152:155], v8, s[36:39], s10 offen sc1
    s_add_u32 s10, s65, 8192
    buffer_load_dwordx4 v[156:159], v8, s[36:39], s10 offen sc1
    s_add_u32 s10, s65, 16384
    buffer_load_dwordx4 v[160:163], v8, s[36:39], s10 offen sc1
    s_add_u32 s10, s65, 24576
    buffer_load_dwordx4 v[164:167], v8, s[36:39], s10 offen sc1
    s_waitcnt vmcnt(0)
    v_and_b32 v3, v152, v156
    v_and_b32 v10, v160, v164
    v_and_b32 v3, v3, v10
    v_and_b32 v3, 1, v3
    v_cmp_eq_u32 vcc, 0, v3
    s_cbranch_vccnz PK_ZS3
PK_ZX3:
    s_mov_b64 exec, -1
    s_branch PK_ZG3
PK_A:
    s_setprio 0
    v_and_b32 v11, 1, v1
    v_mul_u32_u24 v11, 0x8000, v11
    v_lshl_or_b32 v11, v11, 16, v11
    s_mov_b32 s66, 0x80008000
    s_mov_b32 s65, 0
    s_mul_i32 s64, s2, 8192
    s_lshl_b32 s10, s80, 11
    s_add_u32 s10, s10, 147456
    v_add_u32 v3, s10, v2
    v_add_u32 v10, 147456, v2
    s_setprio 3
    s_mov_b32 s100, 1
    s_waitcnt vmcnt(2)
    v_cmp_ne_u64 vcc, s[22:23], v[200:201]
    s_nop 0
    s_cmp_eq_u32 vcc_lo, 0
    s_cbranch_scc1 PK_AGO
    s_mov_b32 s100, 0
    s_mov_b32 exec_hi, 0
    buffer_load_dwordx2 v[200:201], v12, s[36:39], s101 offen sc1
    s_mov_b32 exec_hi, -1
    s_waitcnt vmcnt(0)
    v_mov_b32 v72, 163788
    v_mov_b32 v73, 1
    s_mov_b64 exec, 1
    ds_add_rtn_u32 v72, v72, v73
    s_waitcnt lgkmcnt(0)
    v_readfirstlane_b32 s11, v72
    s_nop 0
    s_cmp_lg_u32 s11, 7
    s_mov_b64 exec, -1
    s_cbranch_scc1 PK_NOML
    s_mov_b64 exec, 0xff
    v_mov_b32 v76, s22
    v_mov_b32 v77, s23
    v_mov_b32 v78, s22
    v_mov_b32 v79, s23
    buffer_store_dwordx4 v[76:79], v2, s[36:39], s77 offen sc1
    s_mov_b64 exec, -1
    s_nop 0
PK_NOML:
    s_movk_i32 s67, 16383
    s_mov_b32 exec_hi, 0
PK_APC:
    v_cmp_ne_u64 vcc, s[22:23], v[200:201]
    s_cbranch_vccz PK_APG
    s_sub_u32 s67, s67, 1
    s_cbranch_scc1 PK_APG
    s_mov_b64 exec, vcc
    s_sleep 4
PK_APL:
    buffer_load_dwordx2 v[200:201], v12, s[36:39], s101 offen sc1
    s_waitcnt vmcnt(0)
    s_branch PK_APC
PK_APG:
    s_mov_b64 exec, -1
PK_AGO:
    s_mul_i32 s3, s2, 8192
    s_lshl_b32 s0, s80, 11
    s_add_u32 s3, s3, s0
    s_add_u32 s0, s3, 7340032
    s_add_u32 s1, s3, 11534336
    buffer_load_dwordx4 v[216:219], v2, s[36:39], s0 offen offset:0 sc1
    buffer_load_dwordx4 v[220:223], v2, s[36:39], s0 offen offset:1024 sc1
    buffer_load_dwordx4 v[152:155], v2, s[36:39], s1 offen offset:0 sc1
    buffer_load_dwordx4 v[156:159], v2, s[36:39], s1 offen offset:1024 sc1
    s_lshl_b32 s10, s80, 10
    s_add_u32 s10, s10, 15532032
    s_add_u32 s11, s10, 4096
    buffer_load_dwordx4 v[16:19], v2, s[36:39], s10 offen sc1
    buffer_load_dwordx4 v[20:23], v2, s[36:39], s11 offen sc1
    s_cmp_lg_u32 s2, 0
    s_cbranch_scc1 PK_NOW2
    s_lshl_b32 s11, s80, 11
    s_add_u32 s11, s11, 13631488
    buffer_load_dwordx4 v[144:147], v2, s[36:39], s11 offen offset:0 sc1
    buffer_load_dwordx4 v[148:151], v2, s[36:39], s11 offen offset:1024 sc1
PK_NOW2:
    s_setprio 0
    s_cmp_eq_u32 s100, 0
    s_cbranch_scc1 PK_NCA
    s_waitcnt vmcnt(6)
    v_mov_b32 v72, 163788
    v_mov_b32 v73, 1
    s_mov_b64 exec, 1
    ds_add_rtn_u32 v72, v72, v73
    s_waitcnt lgkmcnt(0)
    v_readfirstlane_b32 s11, v72
    s_nop 0
    s_cmp_lg_u32 s11, 7
    s_mov_b64 exec, -1
    s_cbranch_scc1 PK_NOMA
    s_mov_b64 exec, 0xff
    v_mov_b32 v76, s22
    v_mov_b32 v77, s23
    v_mov_b32 v78, s22
    v_mov_b32 v79, s23
    buffer_store_dwordx4 v[76:79], v2, s[36:39], s77 offen sc1
    s_mov_b64 exec, -1
    s_nop 0
PK_NOMA:
PK_NCA:
    s_waitcnt vmcnt(4)
    ds_write_b128 v3, v[216:219]
    ds_write_b128 v3, v[220:223] offset:1024
    s_waitcnt lgkmcnt(0)
    v_mov_b32 v72, 163792
    v_mov_b32 v73, 1
    s_mov_b64 exec, 1
    ds_add_u32 v72, v73
    s_mov_b64 exec, -1
    v_xor_b32 v216, v11, v208
    v_xor_b32 v217, v11, v209
    v_xor_b32 v218, v11, v210
    v_xor_b32 v219, v11, v211
    v_xor_b32 v220, v11, v212
    v_xor_b32 v221, v11, v213
    v_xor_b32 v222, v11, v214
    v_xor_b32 v223, v11, v215
    v_xor_b32 v200, v11, v192
    v_xor_b32 v201, v11, v193
    v_xor_b32 v202, v11, v194
    v_xor_b32 v203, v11, v195
    v_xor_b32 v204, v11, v196
    v_xor_b32 v205, v11, v197
    v_xor_b32 v206, v11, v198
    v_xor_b32 v207, v11, v199
    v_mov_b32 v72, 163792
PK_SPIN6:
    ds_read_b32 v73, v72
    s_waitcnt lgkmcnt(0)
    v_readfirstlane_b32 s11, v73
    s_nop 0
    s_cmp_lt_u32 s11, 4
    s_cbranch_scc1 PK_SPIN6
    ds_read_b128 v[24:27], v10 offset:0
    ds_read_b128 v[28:31], v10 offset:1024
    ds_read_b128 v[32:35], v10 offset:2048
    ds_read_b128 v[36:39], v10 offset:3072
    ds_read_b128 v[40:43], v10 offset:4096
    ds_read_b128 v[44:47], v10 offset:5120
    ds_read_b128 v[48:51], v10 offset:6144
    ds_read_b128 v[52:55], v10 offset:7168
    v_xor_b32 v180, v11, v176
    v_xor_b32 v181, v11, v177
    v_xor_b32 v182, v11, v178
    v_xor_b32 v183, v11, v179
    v_mov_b32 v184, v176
    v_xor_b32 v185, s66, v177
    v_mov_b32 v186, v178
    v_xor_b32 v187, s66, v179
    v_mov_b32 v188, v180
    v_xor_b32 v189, s66, v181
    v_mov_b32 v190, v182
    v_xor_b32 v191, s66, v183
    v_xor_b32 v164, v11, v160
    v_xor_b32 v165, v11, v161
    v_xor_b32 v166, v11, v162
    v_xor_b32 v167, v11, v163
    v_mov_b32 v168, v160
    v_xor_b32 v169, s66, v161
    v_mov_b32 v170, v162
    v_xor_b32 v171, s66, v163
    v_mov_b32 v172, v164
    v_xor_b32 v173, s66, v165
    v_mov_b32 v174, v166
    v_xor_b32 v175, s66, v167
    s_setprio 2
    s_waitcnt lgkmcnt(0)
    v_mov_b32 v72, 163792
    v_mov_b32 v73, 1
    s_mov_b64 exec, 1
    ds_add_u32 v72, v73
    s_mov_b64 exec, -1
    s_cmp_lg_u32 s2, 0
    s_cbranch_scc1 PK_PASS
    v_perm_b32 v128, v25, v24, s71
    v_perm_b32 v129, v27, v26, s71
    v_perm_b32 v130, v29, v28, s71
    v_perm_b32 v131, v31, v30, s71
    v_perm_b32 v132, v33, v32, s71
    v_perm_b32 v133, v35, v34, s71
    v_perm_b32 v134, v37, v36, s71
    v_perm_b32 v135, v39, v38, s71
    v_perm_b32 v136, v41, v40, s71
    v_perm_b32 v137, v43, v42, s71
    v_perm_b32 v138, v45, v44, s71
    v_perm_b32 v139, v47, v46, s71
    v_perm_b32 v140, v49, v48, s71
    v_perm_b32 v141, v51, v50, s71
    v_perm_b32 v142, v53, v52, s71
    v_perm_b32 v143, v55, v54, s71
    v_and_b32 v24, 0xffff, v24
    v_and_b32 v25, 0xffff, v25
    v_and_b32 v26, 0xffff, v26
    v_and_b32 v27, 0xffff, v27
    v_and_b32 v28, 0xffff, v28
    v_and_b32 v29, 0xffff, v29
    v_and_b32 v30, 0xffff, v30
    v_and_b32 v31, 0xffff, v31
    v_and_b32 v32, 0xffff, v32
    v_and_b32 v33, 0xffff, v33
    v_and_b32 v34, 0xffff, v34
    v_and_b32 v35, 0xffff, v35
    v_and_b32 v36, 0xffff, v36
    v_and_b32 v37, 0xffff, v37
    v_and_b32 v38, 0xffff, v38
    v_and_b32 v39, 0xffff, v39
    v_and_b32 v40, 0xffff, v40
    v_and_b32 v41, 0xffff, v41
    v_and_b32 v42, 0xffff, v42
    v_and_b32 v43, 0xffff, v43
    v_and_b32 v44, 0xffff, v44
    v_and_b32 v45, 0xffff, v45
    v_and_b32 v46, 0xffff, v46
    v_and_b32 v47, 0xffff, v47
    v_and_b32 v48, 0xffff, v48
    v_and_b32 v49, 0xffff, v49
    v_and_b32 v50, 0xffff, v50
    v_and_b32 v51, 0xffff, v51
    v_and_b32 v52, 0xffff, v52
    v_and_b32 v53, 0xffff, v53
    v_and_b32 v54, 0xffff, v54
    v_and_b32 v55, 0xffff, v55
    s_nop 1
PK_PASS:
    v_mfma_f32_16x16x32_bf16 v[88:91], v[24:27], v[208:211], 0
    v_mfma_f32_16x16x32_bf16 v[92:95], v[24:27], v[192:195], 0
    v_mfma_f32_16x16x32_bf16 v[88:91], v[28:31], v[212:215], v[88:91]
    v_mfma_f32_16x16x32_bf16 v[92:95], v[28:31], v[196:199], v[92:95]
    v_mfma_f32_16x16x32_bf16 v[88:91], v[32:35], v[216:219], v[88:91]
    v_mfma_f32_16x16x32_bf16 v[92:95], v[32:35], v[200:203], v[92:95]
    v_mfma_f32_16x16x32_bf16 v[88:91], v[36:39], v[220:223], v[88:91]
    v_mfma_f32_16x16x32_bf16 v[92:95], v[36:39], v[204:207], v[92:95]
    v_mfma_f32_16x16x32_bf16 v[96:99], v[40:43], v[208:211], 0
    v_mfma_f32_16x16x32_bf16 v[100:103], v[40:43], v[192:195], 0
    v_mfma_f32_16x16x32_bf16 v[96:99], v[44:47], v[212:215], v[96:99]
    v_mfma_f32_16x16x32_bf16 v[100:103], v[44:47], v[196:199], v[100:103]
    v_mfma_f32_16x16x32_bf16 v[96:99], v[48:51], v[216:219], v[96:99]
    v_mfma_f32_16x16x32_bf16 v[100:103], v[48:51], v[200:203], v[100:103]
    v_mfma_f32_16x16x32_bf16 v[96:99], v[52:55], v[220:223], v[96:99]
    v_mfma_f32_16x16x32_bf16 v[100:103], v[52:55], v[204:207], v[100:103]
    v_pk_mul_f32 v[72:73], v[92:93], v[232:233]
    v_pk_mul_f32 v[76:77], v[88:89], v[232:233]
    v_pk_mul_f32 v[74:75], v[94:95], v[234:235]
    v_pk_mul_f32 v[78:79], v[90:91], v[234:235]
    v_pk_fma_f32 v[72:73], v[88:89], v[224:225], v[72:73]
    v_pk_fma_f32 v[76:77], v[92:93], v[224:225], v[76:77] neg_lo:[0,0,1] neg_hi:[0,0,1]
    v_pk_fma_f32 v[74:75], v[90:91], v[226:227], v[74:75]
    v_pk_fma_f32 v[78:79], v[94:95], v[226:227], v[78:79] neg_lo:[0,0,1] neg_hi:[0,0,1]
    v_cvt_pk_bf16_f32 v120, v72, v76
    v_cvt_pk_bf16_f32 v121, v73, v77
    v_cvt_pk_bf16_f32 v122, v74, v78
    v_cvt_pk_bf16_f32 v123, v75, v79
    v_pk_mul_f32 v[72:73], v[100:101], v[236:237]
    v_pk_mul_f32 v[76:77], v[96:97], v[236:237]
    v_pk_mul_f32 v[74:75], v[102:103], v[238:239]
    v_pk_mul_f32 v[78:79], v[98:99], v[238:239]
    v_pk_fma_f32 v[72:73], v[96:97], v[228:229], v[72:73]
    v_pk_fma_f32 v[76:77], v[100:101], v[228:229], v[76:77] neg_lo:[0,0,1] neg_hi:[0,0,1]
    v_pk_fma_f32 v[74:75], v[98:99], v[230:231], v[74:75]
    v_pk_fma_f32 v[78:79], v[102:103], v[230:231], v[78:79] neg_lo:[0,0,1] neg_hi:[0,0,1]
    v_cvt_pk_bf16_f32 v124, v72, v76
    v_cvt_pk_bf16_f32 v125, v73, v77
    v_cvt_pk_bf16_f32 v126, v74, v78
    v_cvt_pk_bf16_f32 v127, v75, v79
    v_mfma_f32_16x16x32_bf16 v[104:107], v[176:179], v[120:123], 0
    v_mfma_f32_16x16x32_bf16 v[108:111], v[160:163], v[120:123], 0
    v_mfma_f32_16x16x32_bf16 v[104:107], v[180:183], v[124:127], v[104:107]
    v_mfma_f32_16x16x32_bf16 v[108:111], v[164:167], v[124:127], v[108:111]
    v_mfma_f32_16x16x32_bf16 v[112:115], v[184:187], v[120:123], 0
    v_mfma_f32_16x16x32_bf16 v[116:119], v[168:171], v[120:123], 0
    v_mfma_f32_16x16x32_bf16 v[112:115], v[188:191], v[124:127], v[112:115]
    v_mfma_f32_16x16x32_bf16 v[116:119], v[172:175], v[124:127], v[116:119]
    s_waitcnt vmcnt(0)
    v_lshlrev_b32 v56, 16, v152
    v_and_b32 v64, 0xffff0000, v152
    v_lshlrev_b32 v57, 16, v153
    v_and_b32 v65, 0xffff0000, v153
    v_lshlrev_b32 v58, 16, v154
    v_and_b32 v66, 0xffff0000, v154
    v_lshlrev_b32 v59, 16, v155
    v_and_b32 v67, 0xffff0000, v155
    v_lshlrev_b32 v60, 16, v156
    v_and_b32 v68, 0xffff0000, v156
    v_lshlrev_b32 v61, 16, v157
    v_and_b32 v69, 0xffff0000, v157
    v_lshlrev_b32 v62, 16, v158
    v_and_b32 v70, 0xffff0000, v158
    v_lshlrev_b32 v63, 16, v159
    v_and_b32 v71, 0xffff0000, v159
    v_pk_mul_f32 v[72:73], v[108:109], v[64:65]
    v_pk_mul_f32 v[76:77], v[104:105], v[64:65]
    v_pk_mul_f32 v[74:75], v[110:111], v[66:67]
    v_pk_mul_f32 v[78:79], v[106:107], v[66:67]
    v_pk_fma_f32 v[72:73], v[104:105], v[56:57], v[72:73] neg_lo:[0,0,1] neg_hi:[0,0,1]
    v_pk_fma_f32 v[76:77], v[108:109], v[56:57], v[76:77]
    v_pk_fma_f32 v[74:75], v[106:107], v[58:59], v[74:75] neg_lo:[0,0,1] neg_hi:[0,0,1]
    v_pk_fma_f32 v[78:79], v[110:111], v[58:59], v[78:79]
    v_cvt_pk_bf16_f32 v120, v76, v72
    v_cvt_pk_bf16_f32 v121, v77, v73
    v_cvt_pk_bf16_f32 v122, v78, v74
    v_cvt_pk_bf16_f32 v123, v79, v75
    v_pk_mul_f32 v[72:73], v[116:117], v[68:69]
    v_pk_mul_f32 v[76:77], v[112:113], v[68:69]
    v_pk_mul_f32 v[74:75], v[118:119], v[70:71]
    v_pk_mul_f32 v[78:79], v[114:115], v[70:71]
    v_pk_fma_f32 v[72:73], v[112:113], v[60:61], v[72:73] neg_lo:[0,0,1] neg_hi:[0,0,1]
    v_pk_fma_f32 v[76:77], v[116:117], v[60:61], v[76:77]
    v_pk_fma_f32 v[74:75], v[114:115], v[62:63], v[74:75] neg_lo:[0,0,1] neg_hi:[0,0,1]
    v_pk_fma_f32 v[78:79], v[118:119], v[62:63], v[78:79]
    v_cvt_pk_bf16_f32 v124, v76, v72
    v_cvt_pk_bf16_f32 v125, v77, v73
    v_cvt_pk_bf16_f32 v126, v78, v74
    v_cvt_pk_bf16_f32 v127, v79, v75
    v_mfma_f32_16x16x32_bf16 v[88:91], v[120:123], v[176:179], 0
    v_mfma_f32_16x16x32_bf16 v[92:95], v[120:123], v[160:163], 0
    v_mfma_f32_16x16x32_bf16 v[88:91], v[124:127], v[180:183], v[88:91]
    v_mfma_f32_16x16x32_bf16 v[92:95], v[124:127], v[164:167], v[92:95]
    v_mfma_f32_16x16x32_bf16 v[96:99], v[120:123], v[184:187], 0
    v_mfma_f32_16x16x32_bf16 v[100:103], v[120:123], v[168:171], 0
    v_mfma_f32_16x16x32_bf16 v[96:99], v[124:127], v[188:191], v[96:99]
    v_mfma_f32_16x16x32_bf16 v[100:103], v[124:127], v[172:175], v[100:103]
    s_nop 3
    v_pk_mul_f32 v[72:73], v[92:93], v[248:249]
    v_pk_mul_f32 v[76:77], v[88:89], v[248:249]
    v_pk_mul_f32 v[74:75], v[94:95], v[250:251]
    v_pk_mul_f32 v[78:79], v[90:91], v[250:251]
    v_pk_fma_f32 v[72:73], v[88:89], v[240:241], v[72:73]
    v_pk_fma_f32 v[76:77], v[92:93], v[240:241], v[76:77] neg_lo:[0,0,1] neg_hi:[0,0,1]
    v_pk_fma_f32 v[74:75], v[90:91], v[242:243], v[74:75]
    v_pk_fma_f32 v[78:79], v[94:95], v[242:243], v[78:79] neg_lo:[0,0,1] neg_hi:[0,0,1]
    v_cvt_pk_bf16_f32 v120, v72, v76
    v_cvt_pk_bf16_f32 v121, v73, v77
    v_cvt_pk_bf16_f32 v122, v74, v78
    v_cvt_pk_bf16_f32 v123, v75, v79
    v_pk_mul_f32 v[72:73], v[100:101], v[252:253]
    v_pk_mul_f32 v[76:77], v[96:97], v[252:253]
    v_pk_mul_f32 v[74:75], v[102:103], v[254:255]
    v_pk_mul_f32 v[78:79], v[98:99], v[254:255]
    v_pk_fma_f32 v[72:73], v[96:97], v[244:245], v[72:73]
    v_pk_fma_f32 v[76:77], v[100:101], v[244:245], v[76:77] neg_lo:[0,0,1] neg_hi:[0,0,1]
    v_pk_fma_f32 v[74:75], v[98:99], v[246:247], v[74:75]
    v_pk_fma_f32 v[78:79], v[102:103], v[246:247], v[78:79] neg_lo:[0,0,1] neg_hi:[0,0,1]
    v_cvt_pk_bf16_f32 v124, v72, v76
    v_cvt_pk_bf16_f32 v125, v73, v77
    v_cvt_pk_bf16_f32 v126, v74, v78
    v_cvt_pk_bf16_f32 v127, v75, v79
    s_lshl_b32 s10, s65, 2
    s_add_u32 s10, s10, 8
    v_mov_b32 v72, 163792
PK_SPIN7:
    ds_read_b32 v73, v72
    s_waitcnt lgkmcnt(0)
    v_readfirstlane_b32 s11, v73
    s_nop 0
    s_cmp_lt_u32 s11, s10
    s_cbranch_scc1 PK_SPIN7
    ds_write_b128 v3, v[120:123]
    ds_write_b128 v3, v[124:127] offset:1024
    s_lshl_b32 s10, s65, 2
    s_add_u32 s10, s10, 4
    s_waitcnt lgkmcnt(0)
    v_mov_b32 v72, 163776
    v_mov_b32 v73, 1
    s_mov_b64 exec, 1
    ds_add_u32 v72, v73
    s_mov_b64 exec, -1
    v_mov_b32 v72, 163776
PK_SPIN1:
    ds_read_b32 v73, v72
    s_waitcnt lgkmcnt(0)
    v_readfirstlane_b32 s11, v73
    s_nop 0
    s_cmp_lt_u32 s11, s10
    s_cbranch_scc1 PK_SPIN1
    ds_read_b128 v[24:27], v10 offset:0
    ds_read_b128 v[40:43], v10 offset:1024
    ds_read_b128 v[28:31], v10 offset:2048
    ds_read_b128 v[44:47], v10 offset:3072
    ds_read_b128 v[32:35], v10 offset:4096
    ds_read_b128 v[48:51], v10 offset:5120
    ds_read_b128 v[36:39], v10 offset:6144
    ds_read_b128 v[52:55], v10 offset:7168
    s_waitcnt lgkmcnt(7)
    v_mfma_f32_16x16x32_bf16 v[104:107], v[208:211], v[24:27], 0
    v_mfma_f32_16x16x32_bf16 v[108:111], v[192:195], v[24:27], 0
    s_waitcnt lgkmcnt(6)
    v_mfma_f32_16x16x32_bf16 v[112:115], v[208:211], v[40:43], 0
    v_mfma_f32_16x16x32_bf16 v[116:119], v[192:195], v[40:43], 0
    s_waitcnt lgkmcnt(5)
    v_mfma_f32_16x16x32_bf16 v[104:107], v[212:215], v[28:31], v[104:107]
    v_mfma_f32_16x16x32_bf16 v[108:111], v[196:199], v[28:31], v[108:111]
    s_waitcnt lgkmcnt(4)
    v_mfma_f32_16x16x32_bf16 v[112:115], v[212:215], v[44:47], v[112:115]
    v_mfma_f32_16x16x32_bf16 v[116:119], v[196:199], v[44:47], v[116:119]
    s_waitcnt lgkmcnt(3)
    v_mfma_f32_16x16x32_bf16 v[104:107], v[216:219], v[32:35], v[104:107]
    v_mfma_f32_16x16x32_bf16 v[108:111], v[200:203], v[32:35], v[108:111]
    s_waitcnt lgkmcnt(2)
    v_mfma_f32_16x16x32_bf16 v[112:115], v[216:219], v[48:51], v[112:115]
    v_mfma_f32_16x16x32_bf16 v[116:119], v[200:203], v[48:51], v[116:119]
    s_waitcnt lgkmcnt(1)
    v_mfma_f32_16x16x32_bf16 v[104:107], v[220:223], v[36:39], v[104:107]
    v_mfma_f32_16x16x32_bf16 v[108:111], v[204:207], v[36:39], v[108:111]
    s_waitcnt lgkmcnt(0)
    v_mfma_f32_16x16x32_bf16 v[112:115], v[220:223], v[52:55], v[112:115]
    v_mfma_f32_16x16x32_bf16 v[116:119], v[204:207], v[52:55], v[116:119]
    s_nop 7
    s_cmp_lg_u32 s2, 0
    s_cbranch_scc1 PK_OUT
    s_cmp_eq_u32 s65, 0
    s_cbranch_scc0 PK_P1
    v_mov_b32 v80, v108
    v_mov_b32 v81, v109
    v_mov_b32 v82, v110
    v_mov_b32 v83, v111
    v_mov_b32 v84, v116
    v_mov_b32 v85, v117
    v_mov_b32 v86, v118
    v_mov_b32 v87, v119
    v_and_b32 v24, 0xffff, v128
    v_lshrrev_b32 v25, 16, v128
    v_and_b32 v26, 0xffff, v129
    v_lshrrev_b32 v27, 16, v129
    v_and_b32 v28, 0xffff, v130
    v_lshrrev_b32 v29, 16, v130
    v_and_b32 v30, 0xffff, v131
    v_lshrrev_b32 v31, 16, v131
    v_and_b32 v32, 0xffff, v132
    v_lshrrev_b32 v33, 16, v132
    v_and_b32 v34, 0xffff, v133
    v_lshrrev_b32 v35, 16, v133
    v_and_b32 v36, 0xffff, v134
    v_lshrrev_b32 v37, 16, v134
    v_and_b32 v38, 0xffff, v135
    v_lshrrev_b32 v39, 16, v135
    v_and_b32 v40, 0xffff, v136
    v_lshrrev_b32 v41, 16, v136
    v_and_b32 v42, 0xffff, v137
    v_lshrrev_b32 v43, 16, v137
    v_and_b32 v44, 0xffff, v138
    v_lshrrev_b32 v45, 16, v138
    v_and_b32 v46, 0xffff, v139
    v_lshrrev_b32 v47, 16, v139
    v_and_b32 v48, 0xffff, v140
    v_lshrrev_b32 v49, 16, v140
    v_and_b32 v50, 0xffff, v141
    v_lshrrev_b32 v51, 16, v141
    v_and_b32 v52, 0xffff, v142
    v_lshrrev_b32 v53, 16, v142
    v_and_b32 v54, 0xffff, v143
    v_lshrrev_b32 v55, 16, v143
    v_mov_b32 v152, v144
    v_mov_b32 v153, v145
    v_mov_b32 v154, v146
    v_mov_b32 v155, v147
    v_mov_b32 v156, v148
    v_mov_b32 v157, v149
    v_mov_b32 v158, v150
    v_mov_b32 v159, v151
    s_mov_b32 s65, 1
    v_mov_b32 v72, 163792
    v_mov_b32 v73, 1
    s_mov_b64 exec, 1
    ds_add_u32 v72, v73
    s_mov_b64 exec, -1
    s_branch PK_PASS
PK_P1:
    v_mov_b32 v104, v108
    v_mov_b32 v108, v80
    v_mov_b32 v105, v109
    v_mov_b32 v109, v81
    v_mov_b32 v106, v110
    v_mov_b32 v110, v82
    v_mov_b32 v107, v111
    v_mov_b32 v111, v83
    v_mov_b32 v112, v116
    v_mov_b32 v116, v84
    v_mov_b32 v113, v117
    v_mov_b32 v117, v85
    v_mov_b32 v114, v118
    v_mov_b32 v118, v86
    v_mov_b32 v115, v119
    v_mov_b32 v119, v87
PK_OUT:
    s_lshl_b32 s10, s80, 10
    s_add_u32 s10, s10, s64
    s_add_u32 s10, s10, 7340032
    s_add_u32 s11, s10, 4096
    s_setprio 3
    s_waitcnt vmcnt(0)
    v_mul_f32 v16, 0x36000000, v16
    v_mul_f32 v17, 0x36000000, v17
    v_mul_f32 v18, 0x36000000, v18
    v_mul_f32 v19, 0x36000000, v19
    v_mul_f32 v20, 0x36000000, v20
    v_mul_f32 v21, 0x36000000, v21
    v_mul_f32 v22, 0x36000000, v22
    v_mul_f32 v23, 0x36000000, v23
    v_pk_mul_f32 v[104:105], v[104:105], v[16:17]
    v_pk_mul_f32 v[106:107], v[106:107], v[18:19]
    v_pk_mul_f32 v[108:109], v[108:109], v[16:17]
    v_pk_mul_f32 v[110:111], v[110:111], v[18:19]
    v_pk_mul_f32 v[112:113], v[112:113], v[20:21]
    v_pk_mul_f32 v[114:115], v[114:115], v[22:23]
    v_pk_mul_f32 v[116:117], v[116:117], v[20:21]
    v_pk_mul_f32 v[118:119], v[118:119], v[22:23]
    v_cvt_pk_bf16_f32 v120, v108, v104
    v_cvt_pk_bf16_f32 v121, v109, v105
    v_cvt_pk_bf16_f32 v122, v110, v106
    v_cvt_pk_bf16_f32 v123, v111, v107
    v_or_b32 v120, 1, v120
    buffer_store_dwordx4 v[120:123], v2, s[36:39], s10 offen sc1
    v_cvt_pk_bf16_f32 v124, v116, v112
    v_cvt_pk_bf16_f32 v125, v117, v113
    v_cvt_pk_bf16_f32 v126, v118, v114
    v_cvt_pk_bf16_f32 v127, v119, v115
    v_or_b32 v124, 1, v124
    buffer_store_dwordx4 v[124:127], v2, s[36:39], s11 offen sc1
    s_setprio 0
    s_nop 1
    s_branch PK_FIN
PK_END:
PK_LAST:
    s_endpgm
.section .rodata,"a"
.p2align 6
.amdhsa_kernel gated_mix__spectral_gfnet__glu_gated_geglu__prompt_kernel
  .amdhsa_next_free_vgpr 256
  .amdhsa_next_free_sgpr 102
  .amdhsa_accum_offset 256
  .amdhsa_group_segment_fixed_size 0
  .amdhsa_kernarg_size 88
  .amdhsa_user_sgpr_count 2
  .amdhsa_user_sgpr_kernarg_segment_ptr 1
  .amdhsa_system_sgpr_workgroup_id_x 1
  .amdhsa_float_denorm_mode_32 3
  .amdhsa_float_denorm_mode_16_64 3
.end_amdhsa_kernel
```
